```python
import torch

def _softmax(x, axis=-1):
    return torch.softmax(x, dim=axis)

def _gelu(x):
    return torch.nn.functional.gelu(x, approximate='tanh')

def _silu(x):
    return torch.nn.functional.silu(x)

def _sigmoid(x):
    return torch.sigmoid(x)

def _layernorm(x, axis=-1, eps=1e-05):
    m = x.mean(dim=axis, keepdim=True)
    v = x.var(dim=axis, keepdim=True, unbiased=False)
    return (x - m) / torch.sqrt(v + eps)

def _scatter_add(tgt, idx, src, axis=0):
    return tgt.clone().index_add_(axis, idx, src)

def _segment_sum(src, seg, n):
    out = torch.zeros((n,) + src.shape[1:], dtype=src.dtype)
    return out.index_add_(0, seg, src)

def _pad(x, pw):
    flat = tuple((v for pair in reversed(pw) for v in pair))
    return torch.nn.functional.pad(x, flat)
kernel_name = 'adaLN_cond__spectral_fnet__dense_activation_relu__prompt'

def setup_inputs():

    _w = lambda a: (lambda t: t.to(torch.bfloat16) if t.is_floating_point() else t)(torch.as_tensor(a))

    def _A_setup():
        B, S, D = (1, 2048, 512)
        ns = torch.arange(S)[:, None] * torch.arange(S)[None, :]
        nd = torch.arange(D)[:, None] * torch.arange(D)[None, :]
        Ws_re = torch.cos(-2.0 * torch.pi * ns / S).to(float)
        Ws_im = torch.sin(-2.0 * torch.pi * ns / S).to(float)
        Wd_re = torch.cos(-2.0 * torch.pi * nd / D).to(float)
        Wd_im = torch.sin(-2.0 * torch.pi * nd / D).to(float)
        return {'x': _w((lambda *s: torch.randn(*s, dtype=torch.bfloat16) * 0.1)(B, S, D)), 'dft_seq_re': _w(Ws_re), 'dft_seq_im': _w(Ws_im), 'dft_hid_re': _w(Wd_re), 'dft_hid_im': _w(Wd_im)}
    _A_in = _A_setup()

    def _B_setup():
        B, S, D, Dff = (1, 2048, 512, 1792)
        return {'x': _w((lambda *s: torch.randn(*s, dtype=torch.bfloat16) * 0.1)(B, S, D)), 'w1': _w((lambda *s: torch.randn(*s, dtype=torch.bfloat16) * 3.2)(D, Dff)), 'w2': _w((lambda *s: torch.randn(*s, dtype=torch.bfloat16) * 3.2)(Dff, D))}
    _B_in = _B_setup()
    return {'A_x': _A_in['x'], 'A_dft_seq_re': _A_in['dft_seq_re'], 'A_dft_seq_im': _A_in['dft_seq_im'], 'A_dft_hid_re': _A_in['dft_hid_re'], 'A_dft_hid_im': _A_in['dft_hid_im'], 'B_x': _B_in['x'], 'B_w1': _B_in['w1'], 'B_w2': _B_in['w2'], 'c': _w((lambda *s: torch.randn(*s, dtype=torch.bfloat16) * 0.4)(1, 512) * 8.0), 'w_mod': _w((lambda *s: torch.randn(*s, dtype=torch.bfloat16) * 0.4)(512, 6 * 512) * 512 ** (-0.5) * 8.0)}

def reference(A_x, A_dft_seq_re, A_dft_seq_im, A_dft_hid_re, A_dft_hid_im, B_x, B_w1, B_w2, c, w_mod):

    def _A_ref(x, dft_seq_re, dft_seq_im, dft_hid_re, dft_hid_im):
        a = torch.einsum('bsd,ed->bse', x, dft_hid_re)
        b = torch.einsum('bsd,ed->bse', x, dft_hid_im)
        y = torch.einsum('ts,bse->bte', dft_seq_re, a) - torch.einsum('ts,bse->bte', dft_seq_im, b)
        return y

    def _B_ref(x, w1, w2):
        h = torch.einsum('bsd,df->bsf', x, w1)
        zero = torch.zeros_like(h)
        h = torch.maximum(h, zero)
        return torch.einsum('bsf,fd->bsd', h, w2)
    x = A_x
    mod = (_silu(c) @ w_mod).reshape(c.shape[0], 6, 1, -1)
    sa, ca, ga, sb, cb, gb = (mod[:, 0].clone(), mod[:, 1].clone(), mod[:, 2].clone(), mod[:, 3].clone(), mod[:, 4].clone(), mod[:, 5].clone())
    h = _layernorm(x, axis=-1) * (1 + ca) + sa
    x = x + ga * _A_ref(h, A_dft_seq_re, A_dft_seq_im, A_dft_hid_re, A_dft_hid_im)
    h = _layernorm(x, axis=-1) * (1 + cb) + sb
    x = x + gb * _B_ref(h, B_w1, B_w2)
    return x
```

```asm
; @launch grid=(256,1,1) block=(512,1,1) lds=163840
.amdgcn_target "amdgcn-amd-amdhsa--gfx950"
.text
.globl adaLN_cond__spectral_fnet__dense_activation_relu__prompt_kernel
.p2align 8
.type adaLN_cond__spectral_fnet__dense_activation_relu__prompt_kernel,@function
adaLN_cond__spectral_fnet__dense_activation_relu__prompt_kernel:
    s_load_dwordx2 s[4:5], s[0:1], 0
    s_load_dwordx2 s[6:7], s[0:1], 96
    s_load_dwordx4 s[8:11], s[0:1], 48
    s_load_dwordx4 s[16:19], s[0:1], 64
    s_load_dwordx4 s[12:15], s[0:1], 80
    s_cmp_ge_u32 s2, 256
    s_cbranch_scc1 L_END
    v_and_b32 v1, 63, v0
    v_lshrrev_b32 v4, 6, v0
    s_nop 0
    v_readfirstlane_b32 s20, v4
    s_and_b32 s22, s2, 7
    s_lshr_b32 s23, s2, 3
    s_mov_b32 s24, 30000000
    v_lshrrev_b32 v2, 4, v1
    v_and_b32 v3, 15, v1
    s_and_b32 s21, s20, 3
    v_lshlrev_b32 v4, 2, v1
    v_add_u32 v4, 162880, v4
    v_mov_b32 v5, 0
    s_mov_b32 exec_hi, 0
    ds_write_b32 v4, v5
    s_mov_b64 exec, -1
    s_waitcnt lgkmcnt(0)
    s_barrier
    s_cmp_ge_u32 s20, 4
    s_cbranch_scc1 L_HELPER
    s_waitcnt lgkmcnt(0)
    s_add_u32 s48, s6, 16384
    s_addc_u32 s49, s7, 0
    s_mov_b32 s50, 11264
    s_mov_b32 s51, 0x20000
    s_and_b32 s52, s2, 15
    s_lshl_b32 s52, s52, 7
    s_add_u32 s52, s52, 1024
    v_mov_b32 v147, s52
    buffer_load_dword v148, v147, s[48:51], 0 offen sc1
    s_mov_b32 s28, s4
    s_mov_b32 s29, s5
    s_mov_b32 s30, 2097152
    s_mov_b32 s31, 0x20000
    s_add_u32 s32, s6, 65536
    s_addc_u32 s33, s7, 0
    s_mov_b32 s34, 2097152
    s_mov_b32 s35, 0x20000
    s_add_u32 s36, s6, 14680064
    s_addc_u32 s37, s7, 0
    s_mov_b32 s38, 24576
    s_mov_b32 s39, 0x20000
    s_cmp_ge_u32 s23, 16
    s_cbranch_scc1 L_NOP1
    s_and_b32 s54, s23, 3
    s_lshl_b32 s54, s54, 3
    s_add_u32 s54, s54, s22
    s_lshr_b32 s55, s23, 2
    v_lshrrev_b32 v5, 3, v1
    v_and_b32 v6, 7, v1
    s_lshl_b32 s52, s21, 4
    v_add_u32 v7, s52, v5
    v_lshlrev_b32 v4, 15, v7
    v_lshl_add_u32 v4, v6, 4, v4
    s_lshl_b32 s52, s54, 10
    v_add_u32 v4, s52, v4
    v_add_u32 v7, 0x40000, v4
    s_lshl_b32 s53, s55, 1
    s_add_u32 s56, s53, 0
    s_and_b32 s56, s56, 7
    s_lshl_b32 s56, s56, 7
    s_add_u32 s57, s53, 1
    s_and_b32 s57, s57, 7
    s_lshl_b32 s57, s57, 7
    s_add_u32 s58, s53, 2
    s_and_b32 s58, s58, 7
    s_lshl_b32 s58, s58, 7
    s_add_u32 s59, s53, 3
    s_and_b32 s59, s59, 7
    s_lshl_b32 s59, s59, 7
    s_add_u32 s60, s53, 4
    s_and_b32 s60, s60, 7
    s_lshl_b32 s60, s60, 7
    s_add_u32 s61, s53, 5
    s_and_b32 s61, s61, 7
    s_lshl_b32 s61, s61, 7
    s_add_u32 s62, s53, 6
    s_and_b32 s62, s62, 7
    s_lshl_b32 s62, s62, 7
    s_add_u32 s63, s53, 7
    s_and_b32 s63, s63, 7
    s_lshl_b32 s63, s63, 7
    buffer_load_dwordx4 v[8:11], v4, s[28:31], s56 offen
    v_and_b32 v104, 31, v1
    v_add_u32 v104, 0, v104
    v_lshrrev_b32 v105, 1, v104
    v_and_b32 v106, 1, v104
    v_cvt_f32_u32 v107, v105
    v_mul_f32 v107, 0x3c800000, v107
    v_mul_u32_u24 v108, s54, v105
    v_cvt_f32_u32 v108, v108
    v_mul_f32 v108, 0x3a000000, v108
    v_cvt_f32_u32 v109, v106
    v_fmac_f32 v108, 0.25, v109
    v_cmp_eq_u32 vcc, 1, v104
    v_mov_b32 v110, 0.5
    v_mov_b32 v111, 0
    buffer_load_dwordx4 v[12:15], v7, s[28:31], s56 offen
    v_cndmask_b32 v107, v107, v110, vcc
    v_cndmask_b32 v108, v108, v111, vcc
    v_lshrrev_b32 v109, 5, v1
    v_cvt_f32_u32 v109, v109
    v_mul_f32 v110, 0x41000000, v107
    v_fma_f32 v109, v109, v110, v108
    v_cos_f32 v112, v109
    v_add_f32 v109, v109, v107
    v_cos_f32 v113, v109
    v_add_f32 v109, v109, v107
    v_cos_f32 v114, v109
    v_add_f32 v109, v109, v107
    v_cos_f32 v115, v109
    v_add_f32 v109, v109, v107
    buffer_load_dwordx4 v[16:19], v4, s[28:31], s57 offen
    v_cos_f32 v116, v109
    v_add_f32 v109, v109, v107
    v_cos_f32 v117, v109
    v_add_f32 v109, v109, v107
    v_cos_f32 v118, v109
    v_add_f32 v109, v109, v107
    v_cos_f32 v119, v109
    v_add_f32 v109, v109, v107
    v_add_f32 v109, v109, v110
    v_cvt_pk_bf16_f32 v72, v112, v113
    v_cvt_pk_bf16_f32 v73, v114, v115
    v_cvt_pk_bf16_f32 v74, v116, v117
    v_cvt_pk_bf16_f32 v75, v118, v119
    v_cos_f32 v112, v109
    buffer_load_dwordx4 v[20:23], v7, s[28:31], s57 offen
    v_add_f32 v109, v109, v107
    v_cos_f32 v113, v109
    v_add_f32 v109, v109, v107
    v_cos_f32 v114, v109
    v_add_f32 v109, v109, v107
    v_cos_f32 v115, v109
    v_add_f32 v109, v109, v107
    v_cos_f32 v116, v109
    v_add_f32 v109, v109, v107
    v_cos_f32 v117, v109
    v_add_f32 v109, v109, v107
    v_cos_f32 v118, v109
    v_add_f32 v109, v109, v107
    v_cos_f32 v119, v109
    buffer_load_dwordx4 v[24:27], v4, s[28:31], s58 offen
    v_add_f32 v109, v109, v107
    v_add_f32 v109, v109, v110
    v_cvt_pk_bf16_f32 v76, v112, v113
    v_cvt_pk_bf16_f32 v77, v114, v115
    v_cvt_pk_bf16_f32 v78, v116, v117
    v_cvt_pk_bf16_f32 v79, v118, v119
    v_cos_f32 v112, v109
    v_add_f32 v109, v109, v107
    v_cos_f32 v113, v109
    v_add_f32 v109, v109, v107
    v_cos_f32 v114, v109
    v_add_f32 v109, v109, v107
    v_cos_f32 v115, v109
    v_add_f32 v109, v109, v107
    buffer_load_dwordx4 v[28:31], v7, s[28:31], s58 offen
    v_cos_f32 v116, v109
    v_add_f32 v109, v109, v107
    v_cos_f32 v117, v109
    v_add_f32 v109, v109, v107
    v_cos_f32 v118, v109
    v_add_f32 v109, v109, v107
    v_cos_f32 v119, v109
    v_add_f32 v109, v109, v107
    v_add_f32 v109, v109, v110
    v_cvt_pk_bf16_f32 v80, v112, v113
    v_cvt_pk_bf16_f32 v81, v114, v115
    v_cvt_pk_bf16_f32 v82, v116, v117
    v_cvt_pk_bf16_f32 v83, v118, v119
    v_cos_f32 v112, v109
    buffer_load_dwordx4 v[32:35], v4, s[28:31], s59 offen
    v_add_f32 v109, v109, v107
    v_cos_f32 v113, v109
    v_add_f32 v109, v109, v107
    v_cos_f32 v114, v109
    v_add_f32 v109, v109, v107
    v_cos_f32 v115, v109
    v_add_f32 v109, v109, v107
    v_cos_f32 v116, v109
    v_add_f32 v109, v109, v107
    v_cos_f32 v117, v109
    v_add_f32 v109, v109, v107
    v_cos_f32 v118, v109
    v_add_f32 v109, v109, v107
    v_cos_f32 v119, v109
    buffer_load_dwordx4 v[36:39], v7, s[28:31], s59 offen
    v_add_f32 v109, v109, v107
    v_add_f32 v109, v109, v110
    v_cvt_pk_bf16_f32 v84, v112, v113
    v_cvt_pk_bf16_f32 v85, v114, v115
    v_cvt_pk_bf16_f32 v86, v116, v117
    v_cvt_pk_bf16_f32 v87, v118, v119
    v_and_b32 v104, 31, v1
    v_add_u32 v104, 32, v104
    v_lshrrev_b32 v105, 1, v104
    v_and_b32 v106, 1, v104
    v_cvt_f32_u32 v107, v105
    v_mul_f32 v107, 0x3c800000, v107
    v_mul_u32_u24 v108, s54, v105
    v_cvt_f32_u32 v108, v108
    buffer_load_dwordx4 v[40:43], v4, s[28:31], s60 offen
    v_mul_f32 v108, 0x3a000000, v108
    v_cvt_f32_u32 v109, v106
    v_fmac_f32 v108, 0.25, v109
    v_lshrrev_b32 v109, 5, v1
    v_cvt_f32_u32 v109, v109
    v_mul_f32 v110, 0x41000000, v107
    v_fma_f32 v109, v109, v110, v108
    v_cos_f32 v112, v109
    v_add_f32 v109, v109, v107
    v_cos_f32 v113, v109
    v_add_f32 v109, v109, v107
    v_cos_f32 v114, v109
    v_add_f32 v109, v109, v107
    v_cos_f32 v115, v109
    buffer_load_dwordx4 v[44:47], v7, s[28:31], s60 offen
    v_add_f32 v109, v109, v107
    v_cos_f32 v116, v109
    v_add_f32 v109, v109, v107
    v_cos_f32 v117, v109
    v_add_f32 v109, v109, v107
    v_cos_f32 v118, v109
    v_add_f32 v109, v109, v107
    v_cos_f32 v119, v109
    v_add_f32 v109, v109, v107
    v_add_f32 v109, v109, v110
    v_cvt_pk_bf16_f32 v88, v112, v113
    v_cvt_pk_bf16_f32 v89, v114, v115
    v_cvt_pk_bf16_f32 v90, v116, v117
    v_cvt_pk_bf16_f32 v91, v118, v119
    buffer_load_dwordx4 v[48:51], v4, s[28:31], s61 offen
    v_cos_f32 v112, v109
    v_add_f32 v109, v109, v107
    v_cos_f32 v113, v109
    v_add_f32 v109, v109, v107
    v_cos_f32 v114, v109
    v_add_f32 v109, v109, v107
    v_cos_f32 v115, v109
    v_add_f32 v109, v109, v107
    v_cos_f32 v116, v109
    v_add_f32 v109, v109, v107
    v_cos_f32 v117, v109
    v_add_f32 v109, v109, v107
    v_cos_f32 v118, v109
    v_add_f32 v109, v109, v107
    buffer_load_dwordx4 v[52:55], v7, s[28:31], s61 offen
    v_cos_f32 v119, v109
    v_add_f32 v109, v109, v107
    v_add_f32 v109, v109, v110
    v_cvt_pk_bf16_f32 v92, v112, v113
    v_cvt_pk_bf16_f32 v93, v114, v115
    v_cvt_pk_bf16_f32 v94, v116, v117
    v_cvt_pk_bf16_f32 v95, v118, v119
    v_cos_f32 v112, v109
    v_add_f32 v109, v109, v107
    v_cos_f32 v113, v109
    v_add_f32 v109, v109, v107
    v_cos_f32 v114, v109
    v_add_f32 v109, v109, v107
    v_cos_f32 v115, v109
    buffer_load_dwordx4 v[56:59], v4, s[28:31], s62 offen
    v_add_f32 v109, v109, v107
    v_cos_f32 v116, v109
    v_add_f32 v109, v109, v107
    v_cos_f32 v117, v109
    v_add_f32 v109, v109, v107
    v_cos_f32 v118, v109
    v_add_f32 v109, v109, v107
    v_cos_f32 v119, v109
    v_add_f32 v109, v109, v107
    v_add_f32 v109, v109, v110
    v_cvt_pk_bf16_f32 v96, v112, v113
    v_cvt_pk_bf16_f32 v97, v114, v115
    v_cvt_pk_bf16_f32 v98, v116, v117
    v_cvt_pk_bf16_f32 v99, v118, v119
    buffer_load_dwordx4 v[60:63], v7, s[28:31], s62 offen
    v_cos_f32 v112, v109
    v_add_f32 v109, v109, v107
    v_cos_f32 v113, v109
    v_add_f32 v109, v109, v107
    v_cos_f32 v114, v109
    v_add_f32 v109, v109, v107
    v_cos_f32 v115, v109
    v_add_f32 v109, v109, v107
    v_cos_f32 v116, v109
    v_add_f32 v109, v109, v107
    v_cos_f32 v117, v109
    v_add_f32 v109, v109, v107
    v_cos_f32 v118, v109
    v_add_f32 v109, v109, v107
    buffer_load_dwordx4 v[64:67], v4, s[28:31], s63 offen
    v_cos_f32 v119, v109
    v_add_f32 v109, v109, v107
    v_add_f32 v109, v109, v110
    v_cvt_pk_bf16_f32 v100, v112, v113
    v_cvt_pk_bf16_f32 v101, v114, v115
    v_cvt_pk_bf16_f32 v102, v116, v117
    v_cvt_pk_bf16_f32 v103, v118, v119
    s_lshl_b32 s52, s21, 4
    v_add_u32 v120, s52, v5
    v_mul_u32_u24 v120, 320, v120
    v_lshl_add_u32 v120, v6, 4, v120
    v_add_u32 v120, 131072, v120
    v_lshrrev_b32 v112, 5, v1
    v_lshlrev_b32 v112, 3, v112
    buffer_load_dwordx4 v[68:71], v7, s[28:31], s63 offen
    v_bfe_u32 v113, v1, 2, 2
    v_add_u32 v112, v112, v113
    v_mul_u32_u24 v121, 320, v112
    v_bfe_u32 v112, v1, 4, 1
    v_lshlrev_b32 v112, 5, v112
    v_add_u32 v121, v121, v112
    v_and_b32 v112, 3, v1
    v_lshl_add_u32 v121, v112, 3, v121
    s_lshl_b32 s52, s21, 6
    s_add_u32 s52, s52, 131072
    v_add_u32 v121, s52, v121
    v_and_b32 v104, 31, v1
    v_mul_u32_u24 v122, 272, v104
    v_lshrrev_b32 v112, 5, v1
    v_lshl_add_u32 v122, v112, 4, v122
    s_lshl_b32 s52, s21, 6
    s_add_u32 s52, s52, 113664
    v_add_u32 v122, s52, v122
    s_lshl_b32 s52, s21, 4
    v_add_u32 v112, s52, v2
    v_mul_u32_u24 v123, 272, v112
    v_lshl_add_u32 v123, v3, 4, v123
    v_add_u32 v123, 113664, v123
    v_lshrrev_b32 v113, 1, v112
    v_lshlrev_b32 v111, 6, v113
    v_and_b32 v113, 1, v112
    v_add_u32 v111, v111, v113
    s_lshl_b32 s52, s54, 1
    v_add_u32 v111, s52, v111
    v_lshlrev_b32 v111, 10, v111
    v_lshl_add_u32 v111, v3, 4, v111
    s_lshl_b32 s53, s55, 8
    s_mov_b32 s52, 0x3f803f80
    s_waitcnt vmcnt(14)
    v_dot2_f32_bf16 v124, v8, s52, 0
    v_dot2_f32_bf16 v125, v8, v8, 0
    v_dot2_f32_bf16 v126, v12, s52, 0
    v_dot2_f32_bf16 v127, v12, v12, 0
    v_dot2_f32_bf16 v124, v9, s52, v124
    v_dot2_f32_bf16 v125, v9, v9, v125
    v_dot2_f32_bf16 v126, v13, s52, v126
    v_dot2_f32_bf16 v127, v13, v13, v127
    v_dot2_f32_bf16 v124, v10, s52, v124
    v_dot2_f32_bf16 v125, v10, v10, v125
    v_dot2_f32_bf16 v126, v14, s52, v126
    v_dot2_f32_bf16 v127, v14, v14, v127
    v_dot2_f32_bf16 v124, v11, s52, v124
    v_dot2_f32_bf16 v125, v11, v11, v125
    v_dot2_f32_bf16 v126, v15, s52, v126
    v_dot2_f32_bf16 v127, v15, v15, v127
    s_waitcnt vmcnt(12)
    v_dot2_f32_bf16 v124, v16, s52, v124
    v_dot2_f32_bf16 v125, v16, v16, v125
    v_dot2_f32_bf16 v126, v20, s52, v126
    v_dot2_f32_bf16 v127, v20, v20, v127
    v_dot2_f32_bf16 v124, v17, s52, v124
    v_dot2_f32_bf16 v125, v17, v17, v125
    v_dot2_f32_bf16 v126, v21, s52, v126
    v_dot2_f32_bf16 v127, v21, v21, v127
    v_dot2_f32_bf16 v124, v18, s52, v124
    v_dot2_f32_bf16 v125, v18, v18, v125
    v_dot2_f32_bf16 v126, v22, s52, v126
    v_dot2_f32_bf16 v127, v22, v22, v127
    v_dot2_f32_bf16 v124, v19, s52, v124
    v_dot2_f32_bf16 v125, v19, v19, v125
    v_dot2_f32_bf16 v126, v23, s52, v126
    v_dot2_f32_bf16 v127, v23, v23, v127
    s_waitcnt vmcnt(10)
    v_dot2_f32_bf16 v124, v24, s52, v124
    v_dot2_f32_bf16 v125, v24, v24, v125
    v_dot2_f32_bf16 v126, v28, s52, v126
    v_dot2_f32_bf16 v127, v28, v28, v127
    v_dot2_f32_bf16 v124, v25, s52, v124
    v_dot2_f32_bf16 v125, v25, v25, v125
    v_dot2_f32_bf16 v126, v29, s52, v126
    v_dot2_f32_bf16 v127, v29, v29, v127
    v_dot2_f32_bf16 v124, v26, s52, v124
    v_dot2_f32_bf16 v125, v26, v26, v125
    v_dot2_f32_bf16 v126, v30, s52, v126
    v_dot2_f32_bf16 v127, v30, v30, v127
    v_dot2_f32_bf16 v124, v27, s52, v124
    v_dot2_f32_bf16 v125, v27, v27, v125
    v_dot2_f32_bf16 v126, v31, s52, v126
    v_dot2_f32_bf16 v127, v31, v31, v127
    s_waitcnt vmcnt(8)
    v_dot2_f32_bf16 v124, v32, s52, v124
    v_dot2_f32_bf16 v125, v32, v32, v125
    v_dot2_f32_bf16 v126, v36, s52, v126
    v_dot2_f32_bf16 v127, v36, v36, v127
    v_dot2_f32_bf16 v124, v33, s52, v124
    v_dot2_f32_bf16 v125, v33, v33, v125
    v_dot2_f32_bf16 v126, v37, s52, v126
    v_dot2_f32_bf16 v127, v37, v37, v127
    v_dot2_f32_bf16 v124, v34, s52, v124
    v_dot2_f32_bf16 v125, v34, v34, v125
    v_dot2_f32_bf16 v126, v38, s52, v126
    v_dot2_f32_bf16 v127, v38, v38, v127
    v_dot2_f32_bf16 v124, v35, s52, v124
    v_dot2_f32_bf16 v125, v35, v35, v125
    v_dot2_f32_bf16 v126, v39, s52, v126
    v_dot2_f32_bf16 v127, v39, v39, v127
    s_waitcnt vmcnt(6)
    v_dot2_f32_bf16 v124, v40, s52, v124
    v_dot2_f32_bf16 v125, v40, v40, v125
    v_dot2_f32_bf16 v126, v44, s52, v126
    v_dot2_f32_bf16 v127, v44, v44, v127
    v_dot2_f32_bf16 v124, v41, s52, v124
    v_dot2_f32_bf16 v125, v41, v41, v125
    v_dot2_f32_bf16 v126, v45, s52, v126
    v_dot2_f32_bf16 v127, v45, v45, v127
    v_dot2_f32_bf16 v124, v42, s52, v124
    v_dot2_f32_bf16 v125, v42, v42, v125
    v_dot2_f32_bf16 v126, v46, s52, v126
    v_dot2_f32_bf16 v127, v46, v46, v127
    v_dot2_f32_bf16 v124, v43, s52, v124
    v_dot2_f32_bf16 v125, v43, v43, v125
    v_dot2_f32_bf16 v126, v47, s52, v126
    v_dot2_f32_bf16 v127, v47, v47, v127
    s_waitcnt vmcnt(4)
    v_dot2_f32_bf16 v124, v48, s52, v124
    v_dot2_f32_bf16 v125, v48, v48, v125
    v_dot2_f32_bf16 v126, v52, s52, v126
    v_dot2_f32_bf16 v127, v52, v52, v127
    v_dot2_f32_bf16 v124, v49, s52, v124
    v_dot2_f32_bf16 v125, v49, v49, v125
    v_dot2_f32_bf16 v126, v53, s52, v126
    v_dot2_f32_bf16 v127, v53, v53, v127
    v_dot2_f32_bf16 v124, v50, s52, v124
    v_dot2_f32_bf16 v125, v50, v50, v125
    v_dot2_f32_bf16 v126, v54, s52, v126
    v_dot2_f32_bf16 v127, v54, v54, v127
    v_dot2_f32_bf16 v124, v51, s52, v124
    v_dot2_f32_bf16 v125, v51, v51, v125
    v_dot2_f32_bf16 v126, v55, s52, v126
    v_dot2_f32_bf16 v127, v55, v55, v127
    s_waitcnt vmcnt(2)
    v_dot2_f32_bf16 v124, v56, s52, v124
    v_dot2_f32_bf16 v125, v56, v56, v125
    v_dot2_f32_bf16 v126, v60, s52, v126
    v_dot2_f32_bf16 v127, v60, v60, v127
    v_dot2_f32_bf16 v124, v57, s52, v124
    v_dot2_f32_bf16 v125, v57, v57, v125
    v_dot2_f32_bf16 v126, v61, s52, v126
    v_dot2_f32_bf16 v127, v61, v61, v127
    v_dot2_f32_bf16 v124, v58, s52, v124
    v_dot2_f32_bf16 v125, v58, v58, v125
    v_dot2_f32_bf16 v126, v62, s52, v126
    v_dot2_f32_bf16 v127, v62, v62, v127
    v_dot2_f32_bf16 v124, v59, s52, v124
    v_dot2_f32_bf16 v125, v59, v59, v125
    v_dot2_f32_bf16 v126, v63, s52, v126
    v_dot2_f32_bf16 v127, v63, v63, v127
    s_waitcnt vmcnt(0)
    v_dot2_f32_bf16 v124, v64, s52, v124
    v_dot2_f32_bf16 v125, v64, v64, v125
    v_dot2_f32_bf16 v126, v68, s52, v126
    v_dot2_f32_bf16 v127, v68, v68, v127
    v_dot2_f32_bf16 v124, v65, s52, v124
    v_dot2_f32_bf16 v125, v65, v65, v125
    v_dot2_f32_bf16 v126, v69, s52, v126
    v_dot2_f32_bf16 v127, v69, v69, v127
    v_dot2_f32_bf16 v124, v66, s52, v124
    v_dot2_f32_bf16 v125, v66, v66, v125
    v_dot2_f32_bf16 v126, v70, s52, v126
    v_dot2_f32_bf16 v127, v70, v70, v127
    v_dot2_f32_bf16 v124, v67, s52, v124
    v_dot2_f32_bf16 v125, v67, v67, v125
    v_dot2_f32_bf16 v126, v71, s52, v126
    v_dot2_f32_bf16 v127, v71, v71, v127
    v_add_f32_dpp v124, v124, v124 quad_perm:[1,0,3,2] row_mask:0xf bank_mask:0xf
    v_add_f32_dpp v125, v125, v125 quad_perm:[1,0,3,2] row_mask:0xf bank_mask:0xf
    v_add_f32_dpp v126, v126, v126 quad_perm:[1,0,3,2] row_mask:0xf bank_mask:0xf
    v_add_f32_dpp v127, v127, v127 quad_perm:[1,0,3,2] row_mask:0xf bank_mask:0xf
    v_add_f32_dpp v124, v124, v124 quad_perm:[2,3,0,1] row_mask:0xf bank_mask:0xf
    v_add_f32_dpp v125, v125, v125 quad_perm:[2,3,0,1] row_mask:0xf bank_mask:0xf
    v_add_f32_dpp v126, v126, v126 quad_perm:[2,3,0,1] row_mask:0xf bank_mask:0xf
    v_add_f32_dpp v127, v127, v127 quad_perm:[2,3,0,1] row_mask:0xf bank_mask:0xf
    v_add_f32_dpp v124, v124, v124 row_half_mirror row_mask:0xf bank_mask:0xf
    v_add_f32_dpp v125, v125, v125 row_half_mirror row_mask:0xf bank_mask:0xf
    v_add_f32_dpp v126, v126, v126 row_half_mirror row_mask:0xf bank_mask:0xf
    v_add_f32_dpp v127, v127, v127 row_half_mirror row_mask:0xf bank_mask:0xf
    v_lshlrev_b32 v128, 16, v8
    v_and_b32 v129, 0xffff0000, v8
    v_lshlrev_b32 v130, 16, v9
    v_and_b32 v131, 0xffff0000, v9
    v_lshlrev_b32 v132, 16, v10
    v_and_b32 v133, 0xffff0000, v10
    v_lshlrev_b32 v134, 16, v11
    v_and_b32 v135, 0xffff0000, v11
    v_lshlrev_b32 v136, 16, v12
    v_and_b32 v137, 0xffff0000, v12
    v_lshlrev_b32 v138, 16, v13
    v_and_b32 v139, 0xffff0000, v13
    v_lshlrev_b32 v140, 16, v14
    v_and_b32 v141, 0xffff0000, v14
    v_lshlrev_b32 v142, 16, v15
    v_and_b32 v143, 0xffff0000, v15
    v_mul_f32 v124, 0x3b000000, v124
    v_mul_f32 v125, 0x3b000000, v125
    v_mul_f32 v126, 0x3b000000, v126
    v_mul_f32 v127, 0x3b000000, v127
    v_fma_f32 v125, -v124, v124, v125
    v_fma_f32 v127, -v126, v126, v127
    v_max_f32 v125, 0, v125
    v_max_f32 v127, 0, v127
    v_add_f32 v125, 0x3727c5ac, v125
    v_add_f32 v127, 0x3727c5ac, v127
    v_rsq_f32 v125, v125
    v_rsq_f32 v127, v127
    v_mul_f32 v124, v124, v125
    v_mul_f32 v126, v126, v127
    v_pk_fma_f32 v[128:129], v[128:129], v[124:125], v[124:125] op_sel:[0,1,0] op_sel_hi:[1,1,0] neg_lo:[0,0,1] neg_hi:[0,0,1]
    v_pk_fma_f32 v[130:131], v[130:131], v[124:125], v[124:125] op_sel:[0,1,0] op_sel_hi:[1,1,0] neg_lo:[0,0,1] neg_hi:[0,0,1]
    v_pk_fma_f32 v[132:133], v[132:133], v[124:125], v[124:125] op_sel:[0,1,0] op_sel_hi:[1,1,0] neg_lo:[0,0,1] neg_hi:[0,0,1]
    v_pk_fma_f32 v[134:135], v[134:135], v[124:125], v[124:125] op_sel:[0,1,0] op_sel_hi:[1,1,0] neg_lo:[0,0,1] neg_hi:[0,0,1]
    v_cvt_pk_bf16_f32 v24, v128, v129
    v_cvt_pk_bf16_f32 v25, v130, v131
    v_cvt_pk_bf16_f32 v26, v132, v133
    v_cvt_pk_bf16_f32 v27, v134, v135
    ds_write_b128 v120, v[24:27] offset:0
    v_pk_fma_f32 v[136:137], v[136:137], v[126:127], v[126:127] op_sel:[0,1,0] op_sel_hi:[1,1,0] neg_lo:[0,0,1] neg_hi:[0,0,1]
    v_pk_fma_f32 v[138:139], v[138:139], v[126:127], v[126:127] op_sel:[0,1,0] op_sel_hi:[1,1,0] neg_lo:[0,0,1] neg_hi:[0,0,1]
    v_pk_fma_f32 v[140:141], v[140:141], v[126:127], v[126:127] op_sel:[0,1,0] op_sel_hi:[1,1,0] neg_lo:[0,0,1] neg_hi:[0,0,1]
    v_pk_fma_f32 v[142:143], v[142:143], v[126:127], v[126:127] op_sel:[0,1,0] op_sel_hi:[1,1,0] neg_lo:[0,0,1] neg_hi:[0,0,1]
    v_cvt_pk_bf16_f32 v28, v136, v137
    v_cvt_pk_bf16_f32 v29, v138, v139
    v_cvt_pk_bf16_f32 v30, v140, v141
    v_cvt_pk_bf16_f32 v31, v142, v143
    ds_write_b128 v120, v[28:31] offset:2560
    v_lshlrev_b32 v128, 16, v16
    v_and_b32 v129, 0xffff0000, v16
    v_lshlrev_b32 v130, 16, v17
    v_and_b32 v131, 0xffff0000, v17
    v_lshlrev_b32 v132, 16, v18
    v_and_b32 v133, 0xffff0000, v18
    v_lshlrev_b32 v134, 16, v19
    v_and_b32 v135, 0xffff0000, v19
    v_lshlrev_b32 v136, 16, v20
    v_and_b32 v137, 0xffff0000, v20
    v_lshlrev_b32 v138, 16, v21
    v_and_b32 v139, 0xffff0000, v21
    v_lshlrev_b32 v140, 16, v22
    v_and_b32 v141, 0xffff0000, v22
    v_lshlrev_b32 v142, 16, v23
    v_and_b32 v143, 0xffff0000, v23
    v_pk_fma_f32 v[128:129], v[128:129], v[124:125], v[124:125] op_sel:[0,1,0] op_sel_hi:[1,1,0] neg_lo:[0,0,1] neg_hi:[0,0,1]
    v_pk_fma_f32 v[130:131], v[130:131], v[124:125], v[124:125] op_sel:[0,1,0] op_sel_hi:[1,1,0] neg_lo:[0,0,1] neg_hi:[0,0,1]
    v_pk_fma_f32 v[132:133], v[132:133], v[124:125], v[124:125] op_sel:[0,1,0] op_sel_hi:[1,1,0] neg_lo:[0,0,1] neg_hi:[0,0,1]
    v_pk_fma_f32 v[134:135], v[134:135], v[124:125], v[124:125] op_sel:[0,1,0] op_sel_hi:[1,1,0] neg_lo:[0,0,1] neg_hi:[0,0,1]
    v_cvt_pk_bf16_f32 v32, v128, v129
    v_cvt_pk_bf16_f32 v33, v130, v131
    v_cvt_pk_bf16_f32 v34, v132, v133
    v_cvt_pk_bf16_f32 v35, v134, v135
    ds_write_b128 v120, v[32:35] offset:128
    v_pk_fma_f32 v[136:137], v[136:137], v[126:127], v[126:127] op_sel:[0,1,0] op_sel_hi:[1,1,0] neg_lo:[0,0,1] neg_hi:[0,0,1]
    v_pk_fma_f32 v[138:139], v[138:139], v[126:127], v[126:127] op_sel:[0,1,0] op_sel_hi:[1,1,0] neg_lo:[0,0,1] neg_hi:[0,0,1]
    v_pk_fma_f32 v[140:141], v[140:141], v[126:127], v[126:127] op_sel:[0,1,0] op_sel_hi:[1,1,0] neg_lo:[0,0,1] neg_hi:[0,0,1]
    v_pk_fma_f32 v[142:143], v[142:143], v[126:127], v[126:127] op_sel:[0,1,0] op_sel_hi:[1,1,0] neg_lo:[0,0,1] neg_hi:[0,0,1]
    v_cvt_pk_bf16_f32 v36, v136, v137
    v_cvt_pk_bf16_f32 v37, v138, v139
    v_cvt_pk_bf16_f32 v38, v140, v141
    v_cvt_pk_bf16_f32 v39, v142, v143
    ds_write_b128 v120, v[36:39] offset:2688
    v_mov_b32 v144, 162880
    v_mov_b32 v145, 1
    s_mov_b64 exec, 1
    ds_add_u32 v144, v145 offset:0
    s_mov_b64 exec, -1
LW1:
    ds_read_b32 v146, v144 offset:0
    s_waitcnt lgkmcnt(0)
    v_readfirstlane_b32 s27, v146
    s_cmp_eq_u32 s24, 0
    s_cbranch_scc1 LW1_X
    s_sub_u32 s24, s24, 1
    s_cmp_lt_u32 s27, 4
    s_cbranch_scc1 LW1
LW1_X:
    ds_read_b64_tr_b16 v[8:9], v121 offset:0
    ds_read_b64_tr_b16 v[10:11], v121 offset:1280
    ds_read_b64_tr_b16 v[12:13], v121 offset:5120
    ds_read_b64_tr_b16 v[14:15], v121 offset:6400
    ds_read_b64_tr_b16 v[16:17], v121 offset:10240
    ds_read_b64_tr_b16 v[18:19], v121 offset:11520
    ds_read_b64_tr_b16 v[20:21], v121 offset:15360
    ds_read_b64_tr_b16 v[22:23], v121 offset:16640
    s_waitcnt lgkmcnt(6)
    v_mfma_f32_32x32x16_bf16 v[24:39], v[8:11], v[72:75], 0
    v_mfma_f32_32x32x16_bf16 v[40:55], v[8:11], v[88:91], 0
    s_waitcnt lgkmcnt(4)
    v_mfma_f32_32x32x16_bf16 v[24:39], v[12:15], v[76:79], v[24:39]
    v_mfma_f32_32x32x16_bf16 v[40:55], v[12:15], v[92:95], v[40:55]
    s_waitcnt lgkmcnt(2)
    v_mfma_f32_32x32x16_bf16 v[24:39], v[16:19], v[80:83], v[24:39]
    v_mfma_f32_32x32x16_bf16 v[40:55], v[16:19], v[96:99], v[40:55]
    s_waitcnt lgkmcnt(0)
    v_mfma_f32_32x32x16_bf16 v[24:39], v[20:23], v[84:87], v[24:39]
    v_mfma_f32_32x32x16_bf16 v[40:55], v[20:23], v[100:103], v[40:55]
    s_nop 10
    v_cvt_pk_bf16_f32 v56, v24, v25
    v_cvt_pk_bf16_f32 v57, v26, v27
    v_cvt_pk_bf16_f32 v58, v28, v29
    v_cvt_pk_bf16_f32 v59, v30, v31
    v_cvt_pk_bf16_f32 v60, v32, v33
    v_cvt_pk_bf16_f32 v61, v34, v35
    v_cvt_pk_bf16_f32 v62, v36, v37
    v_cvt_pk_bf16_f32 v63, v38, v39
    v_permlane32_swap_b32 v56, v58
    v_permlane32_swap_b32 v57, v59
    v_permlane32_swap_b32 v60, v62
    v_permlane32_swap_b32 v61, v63
    ds_write_b128 v122, v[56:59] offset:0
    ds_write_b128 v122, v[60:63] offset:32
    v_cvt_pk_bf16_f32 v64, v40, v41
    v_cvt_pk_bf16_f32 v65, v42, v43
    v_cvt_pk_bf16_f32 v66, v44, v45
    v_cvt_pk_bf16_f32 v67, v46, v47
    v_cvt_pk_bf16_f32 v68, v48, v49
    v_cvt_pk_bf16_f32 v69, v50, v51
    v_cvt_pk_bf16_f32 v70, v52, v53
    v_cvt_pk_bf16_f32 v71, v54, v55
    v_permlane32_swap_b32 v64, v66
    v_permlane32_swap_b32 v65, v67
    v_permlane32_swap_b32 v68, v70
    v_permlane32_swap_b32 v69, v71
    ds_write_b128 v122, v[64:67] offset:8704
    ds_write_b128 v122, v[68:71] offset:8736
    v_mov_b32 v144, 162880
    v_mov_b32 v145, 1
    s_mov_b64 exec, 1
    ds_add_u32 v144, v145 offset:4
    s_mov_b64 exec, -1
LW2:
    ds_read_b32 v146, v144 offset:4
    s_waitcnt lgkmcnt(0)
    v_readfirstlane_b32 s27, v146
    s_cmp_eq_u32 s24, 0
    s_cbranch_scc1 LW2_X
    s_sub_u32 s24, s24, 1
    s_cmp_lt_u32 s27, 4
    s_cbranch_scc1 LW2
LW2_X:
    ds_read_b128 v[8:11], v123 offset:0
    ds_read_b128 v[12:15], v123 offset:1088
    ds_read_b128 v[16:19], v123 offset:2176
    ds_read_b128 v[20:23], v123 offset:3264
    s_waitcnt lgkmcnt(3)
    buffer_store_dwordx4 v[8:11], v111, s[32:35], s53 offen sc1
    s_add_u32 s53, s53, 131072
    s_waitcnt lgkmcnt(2)
    buffer_store_dwordx4 v[12:15], v111, s[32:35], s53 offen sc1
    s_add_u32 s53, s53, 131072
    s_waitcnt lgkmcnt(1)
    buffer_store_dwordx4 v[16:19], v111, s[32:35], s53 offen sc1
    s_add_u32 s53, s53, 131072
    s_waitcnt lgkmcnt(0)
    buffer_store_dwordx4 v[20:23], v111, s[32:35], s53 offen sc1
    s_branch L_P1D
L_NOP1:
    s_cmp_lt_u32 s23, 28
    s_cbranch_scc1 L_NOCPF
    s_getpc_b64 s[40:41]
L_PCREF:
    s_sub_u32 s40, s40, L_PCREF-adaLN_cond__spectral_fnet__dense_activation_relu__prompt_kernel
    s_subb_u32 s41, s41, 0
    s_mov_b32 s42, L_CODE_END-adaLN_cond__spectral_fnet__dense_activation_relu__prompt_kernel
    s_mov_b32 s43, 0x20000
    v_lshlrev_b32 v8, 4, v1
    s_sub_u32 s52, s23, 28
    s_lshl_b32 s52, s52, 2
    s_add_u32 s52, s52, s21
    s_mul_i32 s52, s52, 3072
    buffer_load_dwordx4 v[12:15], v8, s[40:43], s52 offen
    buffer_load_dwordx4 v[12:15], v8, s[40:43], s52 offen offset:1024
    buffer_load_dwordx4 v[12:15], v8, s[40:43], s52 offen offset:2048
    s_mov_b32 s40, s6
    s_mov_b32 s41, s7
    s_mov_b32 s42, 14704640
    s_mov_b32 s43, 0x20000
    v_lshlrev_b32 v9, 21, v1
    buffer_load_dword v70, v9, s[40:43], 0 offen sc1
    s_mov_b32 s40, s12
    s_mov_b32 s41, s13
    s_mov_b32 s42, 2097152
    s_mov_b32 s43, 0x20000
    buffer_load_dword v70, v9, s[40:43], 0 offen sc1
    s_mov_b32 s40, s10
    s_mov_b32 s41, s11
    s_mov_b32 s42, 1835008
    s_mov_b32 s43, 0x20000
    buffer_load_dword v70, v9, s[40:43], 0 offen
L_NOCPF:
    s_cmp_ge_u32 s23, 28
    s_cbranch_scc1 MOD_XC
    s_cmp_lt_u32 s23, 16
    s_cbranch_scc1 MOD_XC
    s_sub_u32 s52, s23, 16
    s_lshl_b32 s52, s52, 3
    s_add_u32 s52, s52, s22
    s_cmp_ge_u32 s52, 48
    s_cselect_b32 s63, 1, 0
    s_mul_i32 s53, s63, 48
    s_sub_u32 s60, s52, s53
    s_mov_b32 s40, s16
    s_mov_b32 s41, s17
    s_mov_b32 s42, 1024
    s_mov_b32 s43, 0x20000
    s_mov_b32 s44, s18
    s_mov_b32 s45, s19
    s_mov_b32 s46, 3145728
    s_mov_b32 s47, 0x20000
    v_lshrrev_b32 v62, 3, v1
    v_and_b32 v63, 7, v1
    s_lshl_b32 s54, s63, 8
    s_lshl_b32 s59, s20, 5
    s_add_u32 s54, s54, s59
    v_add_u32 v10, s54, v62
    v_mul_u32_u24 v11, 6144, v10
    v_lshl_add_u32 v11, v63, 4, v11
    s_lshl_b32 s59, s60, 7
    v_lshlrev_b32 v10, 1, v10
    buffer_load_dwordx4 v[16:19], v11, s[44:47], s59 offen
    s_add_u32 s59, s59, 49152
    buffer_load_dwordx4 v[20:23], v11, s[44:47], s59 offen
    s_add_u32 s59, s59, 49152
    buffer_load_dwordx4 v[24:27], v11, s[44:47], s59 offen
    s_add_u32 s59, s59, 49152
    buffer_load_dwordx4 v[28:31], v11, s[44:47], s59 offen
    buffer_load_ushort v32, v10, s[40:43], 0 offen offset:0
    buffer_load_ushort v33, v10, s[40:43], 0 offen offset:16
    buffer_load_ushort v34, v10, s[40:43], 0 offen offset:32
    buffer_load_ushort v35, v10, s[40:43], 0 offen offset:48
    s_waitcnt vmcnt(0)
    v_lshlrev_b32 v32, 16, v32
    v_lshlrev_b32 v33, 16, v33
    v_lshlrev_b32 v34, 16, v34
    v_lshlrev_b32 v35, 16, v35
    v_mul_f32 v48, 0xbfb8aa3b, v32
    v_mul_f32 v49, 0xbfb8aa3b, v33
    v_mul_f32 v50, 0xbfb8aa3b, v34
    v_mul_f32 v51, 0xbfb8aa3b, v35
    v_exp_f32 v48, v48
    v_exp_f32 v49, v49
    v_exp_f32 v50, v50
    v_exp_f32 v51, v51
    v_add_f32 v48, 1.0, v48
    v_add_f32 v49, 1.0, v49
    v_add_f32 v50, 1.0, v50
    v_add_f32 v51, 1.0, v51
    v_rcp_f32 v48, v48
    v_rcp_f32 v49, v49
    v_rcp_f32 v50, v50
    v_rcp_f32 v51, v51
    v_mul_f32 v48, v32, v48
    v_mul_f32 v49, v33, v49
    v_mul_f32 v50, v34, v50
    v_mul_f32 v51, v35, v51
    v_cvt_pk_bf16_f32 v32, v48, 0
    v_cvt_pk_bf16_f32 v33, v49, 0
    v_cvt_pk_bf16_f32 v34, v50, 0
    v_cvt_pk_bf16_f32 v35, v51, 0
    v_lshlrev_b32 v36, 16, v32
    v_lshlrev_b32 v37, 16, v33
    v_lshlrev_b32 v38, 16, v34
    v_lshlrev_b32 v39, 16, v35
    v_dot2_f32_bf16 v40, v16, v32, 0
    v_dot2_f32_bf16 v41, v16, v36, 0
    v_dot2_f32_bf16 v42, v17, v32, 0
    v_dot2_f32_bf16 v43, v17, v36, 0
    v_dot2_f32_bf16 v44, v18, v32, 0
    v_dot2_f32_bf16 v45, v18, v36, 0
    v_dot2_f32_bf16 v46, v19, v32, 0
    v_dot2_f32_bf16 v47, v19, v36, 0
    v_dot2_f32_bf16 v40, v20, v33, v40
    v_dot2_f32_bf16 v41, v20, v37, v41
    v_dot2_f32_bf16 v42, v21, v33, v42
    v_dot2_f32_bf16 v43, v21, v37, v43
    v_dot2_f32_bf16 v44, v22, v33, v44
    v_dot2_f32_bf16 v45, v22, v37, v45
    v_dot2_f32_bf16 v46, v23, v33, v46
    v_dot2_f32_bf16 v47, v23, v37, v47
    v_dot2_f32_bf16 v40, v24, v34, v40
    v_dot2_f32_bf16 v41, v24, v38, v41
    v_dot2_f32_bf16 v42, v25, v34, v42
    v_dot2_f32_bf16 v43, v25, v38, v43
    v_dot2_f32_bf16 v44, v26, v34, v44
    v_dot2_f32_bf16 v45, v26, v38, v45
    v_dot2_f32_bf16 v46, v27, v34, v46
    v_dot2_f32_bf16 v47, v27, v38, v47
    v_dot2_f32_bf16 v40, v28, v35, v40
    v_dot2_f32_bf16 v41, v28, v39, v41
    v_dot2_f32_bf16 v42, v29, v35, v42
    v_dot2_f32_bf16 v43, v29, v39, v43
    v_dot2_f32_bf16 v44, v30, v35, v44
    v_dot2_f32_bf16 v45, v30, v39, v45
    v_dot2_f32_bf16 v46, v31, v35, v46
    v_dot2_f32_bf16 v47, v31, v39, v47
    v_add_f32_dpp v40, v40, v40 row_ror:8 row_mask:0xf bank_mask:0xf
    v_add_f32_dpp v41, v41, v41 row_ror:8 row_mask:0xf bank_mask:0xf
    v_add_f32_dpp v42, v42, v42 row_ror:8 row_mask:0xf bank_mask:0xf
    v_add_f32_dpp v43, v43, v43 row_ror:8 row_mask:0xf bank_mask:0xf
    v_add_f32_dpp v44, v44, v44 row_ror:8 row_mask:0xf bank_mask:0xf
    v_add_f32_dpp v45, v45, v45 row_ror:8 row_mask:0xf bank_mask:0xf
    v_add_f32_dpp v46, v46, v46 row_ror:8 row_mask:0xf bank_mask:0xf
    v_add_f32_dpp v47, v47, v47 row_ror:8 row_mask:0xf bank_mask:0xf
    v_mov_b32 v48, v40
    v_mov_b32 v49, v41
    v_mov_b32 v50, v42
    v_mov_b32 v51, v43
    v_mov_b32 v52, v44
    v_mov_b32 v53, v45
    v_mov_b32 v54, v46
    v_mov_b32 v55, v47
    v_permlane16_swap_b32 v40, v48
    v_permlane16_swap_b32 v41, v49
    v_permlane16_swap_b32 v42, v50
    v_permlane16_swap_b32 v43, v51
    v_permlane16_swap_b32 v44, v52
    v_permlane16_swap_b32 v45, v53
    v_permlane16_swap_b32 v46, v54
    v_permlane16_swap_b32 v47, v55
    v_add_f32 v40, v40, v48
    v_add_f32 v41, v41, v49
    v_add_f32 v42, v42, v50
    v_add_f32 v43, v43, v51
    v_add_f32 v44, v44, v52
    v_add_f32 v45, v45, v53
    v_add_f32 v46, v46, v54
    v_add_f32 v47, v47, v55
    v_mov_b32 v48, v40
    v_mov_b32 v49, v41
    v_mov_b32 v50, v42
    v_mov_b32 v51, v43
    v_mov_b32 v52, v44
    v_mov_b32 v53, v45
    v_mov_b32 v54, v46
    v_mov_b32 v55, v47
    v_permlane32_swap_b32 v40, v48
    v_permlane32_swap_b32 v41, v49
    v_permlane32_swap_b32 v42, v50
    v_permlane32_swap_b32 v43, v51
    v_permlane32_swap_b32 v44, v52
    v_permlane32_swap_b32 v45, v53
    v_permlane32_swap_b32 v46, v54
    v_permlane32_swap_b32 v47, v55
    v_add_f32 v40, v40, v48
    v_add_f32 v41, v41, v49
    v_add_f32 v42, v42, v50
    v_add_f32 v43, v43, v51
    v_add_f32 v44, v44, v52
    v_add_f32 v45, v45, v53
    v_add_f32 v46, v46, v54
    v_add_f32 v47, v47, v55
    v_mov_b32 v60, v40
    v_cmp_eq_u32 vcc, 1, v62
    s_nop 1
    v_cndmask_b32 v60, v60, v41, vcc
    v_cmp_eq_u32 vcc, 2, v62
    s_nop 1
    v_cndmask_b32 v60, v60, v42, vcc
    v_cmp_eq_u32 vcc, 3, v62
    s_nop 1
    v_cndmask_b32 v60, v60, v43, vcc
    v_cmp_eq_u32 vcc, 4, v62
    s_nop 1
    v_cndmask_b32 v60, v60, v44, vcc
    v_cmp_eq_u32 vcc, 5, v62
    s_nop 1
    v_cndmask_b32 v60, v60, v45, vcc
    v_cmp_eq_u32 vcc, 6, v62
    s_nop 1
    v_cndmask_b32 v60, v60, v46, vcc
    v_cmp_eq_u32 vcc, 7, v62
    s_nop 1
    v_cndmask_b32 v60, v60, v47, vcc
    v_lshlrev_b32 v61, 3, v63
    v_add_u32 v61, v61, v62
    v_lshlrev_b32 v61, 2, v61
    s_lshl_b32 s52, s20, 8
    s_add_u32 s52, s52, 158784
    v_add_u32 v61, s52, v61
    ds_write_b32 v61, v60
    v_mov_b32 v12, 162880
    v_mov_b32 v13, 1
    s_mov_b64 exec, 1
    ds_add_rtn_u32 v14, v12, v13 offset:88
    s_mov_b64 exec, -1
    s_waitcnt lgkmcnt(0)
    v_readfirstlane_b32 s27, v14
    s_cmp_lg_u32 s27, 7
    s_cbranch_scc1 MOD_XC
    v_lshlrev_b32 v61, 2, v1
    v_add_u32 v12, 158784, v61
    ds_read_b32 v16, v12 offset:0
    ds_read_b32 v17, v12 offset:256
    ds_read_b32 v18, v12 offset:512
    ds_read_b32 v19, v12 offset:768
    ds_read_b32 v20, v12 offset:1024
    ds_read_b32 v21, v12 offset:1280
    ds_read_b32 v22, v12 offset:1536
    ds_read_b32 v23, v12 offset:1792
    s_lshl_b32 s52, s60, 8
    s_mul_i32 s53, s63, 12288
    s_add_u32 s52, s52, s53
    s_add_u32 s40, s6, 14680064
    s_addc_u32 s41, s7, 0
    s_mov_b32 s42, 24576
    s_mov_b32 s43, 0x20000
    s_waitcnt lgkmcnt(0)
    v_add_f32 v16, v16, v17
    v_add_f32 v18, v18, v19
    v_add_f32 v20, v20, v21
    v_add_f32 v22, v22, v23
    v_add_f32 v16, v16, v18
    v_add_f32 v20, v20, v22
    v_add_f32 v16, v16, v20
    buffer_store_dword v16, v61, s[40:43], s52 offen sc1
MOD_XC:
L_P1D:
    s_lshl_b32 s54, s22, 2
    s_and_b32 s55, s23, 3
    s_add_u32 s54, s54, s55
    s_lshr_b32 s55, s23, 2
    s_lshl_b32 s56, s55, 2
    s_add_u32 s56, s56, s21
    s_lshl_b32 s57, s56, 6
    s_cmp_eq_u32 s54, 0
    s_cbranch_scc1 P2_SLOT0
    s_add_u32 s58, s54, s57
    s_sub_u32 s59, 2048, s58
    s_branch P2_TOKD
P2_SLOT0:
    s_cmp_lt_u32 s56, 16
    s_cbranch_scc1 P2_SLOT0A
    s_sub_u32 s58, s57, 992
    s_sub_u32 s59, 2048, s58
    s_branch P2_TOKD
P2_SLOT0A:
    s_mov_b32 s58, s57
    s_sub_u32 s59, 2048, s57
    s_cmp_eq_u32 s56, 0
    s_cselect_b32 s59, 1024, s59
P2_TOKD:
    s_lshl_b32 s58, s58, 10
    s_lshl_b32 s59, s59, 10
    s_or_b32 s63, s54, s56
    v_lshlrev_b32 v6, 4, v1
    buffer_load_dwordx4 v[152:155], v6, s[28:31], s58 offen
    buffer_load_dwordx4 v[156:159], v6, s[28:31], s59 offen
    s_waitcnt vmcnt(0)
    v_readfirstlane_b32 s26, v148
    s_mov_b32 s40, s14
    s_mov_b32 s41, s15
    s_mov_b32 s42, 256
    s_mov_b32 s43, 0x20000
    v_mov_b32 v12, 162880
    v_mov_b32 v13, 1
    s_mov_b64 exec, 1
    ds_add_rtn_u32 v14, v12, v13 offset:8
    s_waitcnt lgkmcnt(0)
    v_readfirstlane_b32 s27, v14
    s_cmp_lg_u32 s27, 7
    s_cbranch_scc1 S1_A
    s_lshl_b32 s52, s22, 5
    v_mov_b32 v14, s52
    buffer_atomic_add v13, v14, s[40:43], 0 offen
S1_A:
    s_mov_b64 exec, -1
    v_lshrrev_b32 v16, 1, v3
    v_and_b32 v17, 1, v3
    s_lshl_b32 s52, s55, 2
    v_add_u32 v16, s52, v16
    v_cvt_f32_u32 v18, v17
    v_mul_f32 v18, 0.25, v18
    v_cvt_f32_u32 v8, v16
    v_mov_b32 v11, 1.0
    v_mov_b32 v15, 1.0
    s_cmp_eq_u32 s54, 0
    s_cbranch_scc1 P2_C0
    v_mul_f32 v8, 0x3d000000, v8
    v_mov_b32 v9, v18
    v_add_f32 v10, 0xbe800000, v18
    s_branch P2_CD
P2_C0:
    s_cmp_lt_u32 s55, 4
    s_cbranch_scc0 P2_C0B
    v_mul_f32 v8, 0x3d000000, v8
    v_mov_b32 v9, v18
    v_mov_b32 v10, 0
    v_mov_b32 v15, 0
    v_cmp_eq_u32 vcc, 0, v16
    v_add_f32 v18, v18, v18
    s_nop 0
    v_cndmask_b32 v8, v8, v18, vcc
    v_mov_b32 v18, 0
    v_cndmask_b32 v9, v9, v18, vcc
    s_branch P2_CD
P2_C0B:
    v_add_f32 v8, v8, v8
    v_add_f32 v8, 0xc1f80000, v8
    v_mul_f32 v8, 0x3c800000, v8
    v_mov_b32 v9, 0
    v_mov_b32 v10, v18
    v_mov_b32 v11, 0
P2_CD:
    v_cmp_gt_u32 vcc, 8, v3
    v_mov_b32 v18, 0
    s_nop 0
    v_cndmask_b32 v11, v18, v11, vcc
    v_cndmask_b32 v15, v18, v15, vcc
    v_lshlrev_b32 v16, 2, v2
    v_cvt_f32_u32 v16, v16
    v_mul_f32 v16, v16, v8
    v_add_f32 v20, v16, v9
    v_add_f32 v21, v16, v10
    v_cos_f32 v20, v20
    v_cos_f32 v21, v21
    v_add_f32 v16, v16, v8
    v_mul_f32 v20, v20, v11
    v_mul_f32 v21, v21, v15
    v_cvt_pk_bf16_f32 v184, v20, v21
    v_add_f32 v22, v16, v9
    v_add_f32 v23, v16, v10
    v_cos_f32 v22, v22
    v_cos_f32 v23, v23
    v_add_f32 v16, v16, v8
    v_mul_f32 v22, v22, v11
    v_mul_f32 v23, v23, v15
    v_cvt_pk_bf16_f32 v185, v22, v23
    v_add_f32 v20, v16, v9
    v_add_f32 v21, v16, v10
    v_cos_f32 v20, v20
    v_cos_f32 v21, v21
    v_add_f32 v16, v16, v8
    v_mul_f32 v20, v20, v11
    v_mul_f32 v21, v21, v15
    v_cvt_pk_bf16_f32 v186, v20, v21
    v_add_f32 v22, v16, v9
    v_add_f32 v23, v16, v10
    v_cos_f32 v22, v22
    v_cos_f32 v23, v23
    v_add_f32 v16, v16, v8
    v_mul_f32 v22, v22, v11
    v_mul_f32 v23, v23, v15
    v_cvt_pk_bf16_f32 v187, v22, v23
    v_mul_f32 v17, 0x41400000, v8
    v_add_f32 v16, v16, v17
    v_add_f32 v20, v16, v9
    v_add_f32 v21, v16, v10
    v_cos_f32 v20, v20
    v_cos_f32 v21, v21
    v_add_f32 v16, v16, v8
    v_mul_f32 v20, v20, v11
    v_mul_f32 v21, v21, v15
    v_cvt_pk_bf16_f32 v188, v20, v21
    v_add_f32 v22, v16, v9
    v_add_f32 v23, v16, v10
    v_cos_f32 v22, v22
    v_cos_f32 v23, v23
    v_add_f32 v16, v16, v8
    v_mul_f32 v22, v22, v11
    v_mul_f32 v23, v23, v15
    v_cvt_pk_bf16_f32 v189, v22, v23
    v_add_f32 v20, v16, v9
    v_add_f32 v21, v16, v10
    v_cos_f32 v20, v20
    v_cos_f32 v21, v21
    v_add_f32 v16, v16, v8
    v_mul_f32 v20, v20, v11
    v_mul_f32 v21, v21, v15
    v_cvt_pk_bf16_f32 v190, v20, v21
    v_add_f32 v22, v16, v9
    v_add_f32 v23, v16, v10
    v_cos_f32 v22, v22
    v_cos_f32 v23, v23
    v_add_f32 v16, v16, v8
    v_mul_f32 v22, v22, v11
    v_mul_f32 v23, v23, v15
    v_cvt_pk_bf16_f32 v191, v22, v23
    v_cvt_f32_u32 v8, v3
    v_mul_f32 v8, 0x3d000000, v8
    v_lshlrev_b32 v9, 3, v2
    v_cvt_f32_u32 v9, v9
    v_mul_f32 v9, v9, v8
    v_add_f32 v10, v9, v8
    v_cos_f32 v16, v9
    v_cos_f32 v17, v10
    v_sin_f32 v18, v9
    v_sin_f32 v19, v10
    v_add_f32 v9, v10, v8
    v_cvt_pk_bf16_f32 v192, v16, v17
    v_cvt_pk_bf16_f32 v200, v18, v19
    v_add_f32 v10, v9, v8
    v_cos_f32 v16, v9
    v_cos_f32 v17, v10
    v_sin_f32 v18, v9
    v_sin_f32 v19, v10
    v_add_f32 v9, v10, v8
    v_cvt_pk_bf16_f32 v193, v16, v17
    v_cvt_pk_bf16_f32 v201, v18, v19
    v_add_f32 v10, v9, v8
    v_cos_f32 v16, v9
    v_cos_f32 v17, v10
    v_sin_f32 v18, v9
    v_sin_f32 v19, v10
    v_add_f32 v9, v10, v8
    v_cvt_pk_bf16_f32 v194, v16, v17
    v_cvt_pk_bf16_f32 v202, v18, v19
    v_add_f32 v10, v9, v8
    v_cos_f32 v16, v9
    v_cos_f32 v17, v10
    v_sin_f32 v18, v9
    v_sin_f32 v19, v10
    v_add_f32 v9, v10, v8
    v_cvt_pk_bf16_f32 v195, v16, v17
    v_cvt_pk_bf16_f32 v203, v18, v19
    v_xor_b32 v196, 0x80000000, v192
    v_xor_b32 v204, 0x80000000, v200
    v_xor_b32 v208, 0x80008000, v200
    v_xor_b32 v212, 0x00008000, v200
    v_xor_b32 v197, 0x80000000, v193
    v_xor_b32 v205, 0x80000000, v201
    v_xor_b32 v209, 0x80008000, v201
    v_xor_b32 v213, 0x00008000, v201
    v_xor_b32 v198, 0x80000000, v194
    v_xor_b32 v206, 0x80000000, v202
    v_xor_b32 v210, 0x80008000, v202
    v_xor_b32 v214, 0x00008000, v202
    v_xor_b32 v199, 0x80000000, v195
    v_xor_b32 v207, 0x80000000, v203
    v_xor_b32 v211, 0x80008000, v203
    v_xor_b32 v215, 0x00008000, v203
    v_lshlrev_b32 v8, 2, v2
    v_add_u32 v9, 0, v3
    v_add_u32 v16, 0, v8
    v_add_u32 v17, 1, v8
    v_add_u32 v18, 2, v8
    v_add_u32 v19, 3, v8
    v_mul_u32_u24 v16, v16, v9
    v_mul_u32_u24 v17, v17, v9
    v_mul_u32_u24 v18, v18, v9
    v_mul_u32_u24 v19, v19, v9
    v_cvt_f32_u32 v16, v16
    v_cvt_f32_u32 v17, v17
    v_cvt_f32_u32 v18, v18
    v_cvt_f32_u32 v19, v19
    v_mul_f32 v16, 0x3b000000, v16
    v_mul_f32 v17, 0x3b000000, v17
    v_mul_f32 v18, 0x3b000000, v18
    v_mul_f32 v19, 0x3b000000, v19
    v_cos_f32 v216, v16
    v_sin_f32 v224, v16
    v_cos_f32 v217, v17
    v_sin_f32 v225, v17
    v_cos_f32 v218, v18
    v_sin_f32 v226, v18
    v_cos_f32 v219, v19
    v_sin_f32 v227, v19
    v_add_u32 v9, 16, v3
    v_add_u32 v16, 0, v8
    v_add_u32 v17, 1, v8
    v_add_u32 v18, 2, v8
    v_add_u32 v19, 3, v8
    v_mul_u32_u24 v16, v16, v9
    v_mul_u32_u24 v17, v17, v9
    v_mul_u32_u24 v18, v18, v9
    v_mul_u32_u24 v19, v19, v9
    v_cvt_f32_u32 v16, v16
    v_cvt_f32_u32 v17, v17
    v_cvt_f32_u32 v18, v18
    v_cvt_f32_u32 v19, v19
    v_mul_f32 v16, 0x3b000000, v16
    v_mul_f32 v17, 0x3b000000, v17
    v_mul_f32 v18, 0x3b000000, v18
    v_mul_f32 v19, 0x3b000000, v19
    v_cos_f32 v220, v16
    v_sin_f32 v228, v16
    v_cos_f32 v221, v17
    v_sin_f32 v229, v17
    v_cos_f32 v222, v18
    v_sin_f32 v230, v18
    v_cos_f32 v223, v19
    v_sin_f32 v231, v19
    v_add_u32 v16, 0, v8
    v_add_u32 v17, 1, v8
    v_add_u32 v18, 2, v8
    v_add_u32 v19, 3, v8
    v_mul_u32_u24 v16, v16, v3
    v_mul_u32_u24 v17, v17, v3
    v_mul_u32_u24 v18, v18, v3
    v_mul_u32_u24 v19, v19, v3
    v_cvt_f32_u32 v16, v16
    v_cvt_f32_u32 v17, v17
    v_cvt_f32_u32 v18, v18
    v_cvt_f32_u32 v19, v19
    v_mul_f32 v16, 0x3d800000, v16
    v_mul_f32 v17, 0x3d800000, v17
    v_mul_f32 v18, 0x3d800000, v18
    v_mul_f32 v19, 0x3d800000, v19
    v_cos_f32 v20, v16
    v_sin_f32 v24, v16
    v_cos_f32 v21, v17
    v_sin_f32 v25, v17
    v_cos_f32 v22, v18
    v_sin_f32 v26, v18
    v_cos_f32 v23, v19
    v_sin_f32 v27, v19
    v_cvt_pk_bf16_f32 v232, v20, v21
    v_cvt_pk_bf16_f32 v234, v24, v25
    v_cvt_pk_bf16_f32 v233, v22, v23
    v_cvt_pk_bf16_f32 v235, v26, v27
    v_xor_b32 v236, 0x80008000, v234
    v_mov_b32 v238, v232
    v_xor_b32 v237, 0x80008000, v235
    v_mov_b32 v239, v233
    v_lshlrev_b32 v248, 12, v2
    v_lshl_add_u32 v248, v3, 4, v248
    s_lshl_b32 s52, s21, 8
    s_add_u32 s52, s52, 131072
    v_add_u32 v248, s52, v248
    v_lshlrev_b32 v8, 3, v2
    v_bfe_u32 v9, v1, 2, 2
    v_add_u32 v8, v8, v9
    v_lshlrev_b32 v249, 5, v8
    v_and_b32 v9, 3, v1
    v_lshl_add_u32 v249, v9, 3, v249
    s_lshl_b32 s52, s21, 11
    s_add_u32 s52, s52, 131072
    v_add_u32 v249, s52, v249
    s_mul_i32 s52, s21, 4880
    s_add_u32 s52, s52, 139264
    v_mul_u32_u24 v250, 144, v3
    v_lshl_add_u32 v250, v2, 4, v250
    v_add_u32 v250, s52, v250
    v_lshrrev_b32 v8, 2, v1
    v_lshlrev_b32 v8, 4, v8
    v_lshl_add_u32 v251, v1, 5, v8
    v_add_u32 v251, s52, v251
    v_sub_u32 v8, 63, v1
    v_lshrrev_b32 v9, 2, v8
    v_lshlrev_b32 v9, 4, v9
    v_lshl_add_u32 v252, v8, 5, v9
    v_add_u32 v252, s52, v252
    v_sub_u32 v8, 64, v1
    v_and_b32 v8, 63, v8
    v_lshrrev_b32 v9, 2, v8
    v_lshlrev_b32 v9, 4, v9
    v_lshl_add_u32 v253, v8, 5, v9
    v_add_u32 v253, s52, v253
    v_add_u32 v254, s52, v6
    v_and_b32 v8, 7, v1
    v_lshrrev_b32 v9, 1, v8
    v_mul_u32_u24 v255, 4880, v9
    v_and_b32 v9, 1, v8
    v_mul_u32_u24 v9, 1088, v9
    v_add_u32 v255, v255, v9
    v_lshrrev_b32 v9, 3, v1
    v_lshl_add_u32 v255, v9, 4, v255
    s_lshr_b32 s52, s21, 1
    s_mul_i32 s52, s52, 2176
    s_and_b32 s53, s21, 1
    s_lshl_b32 s53, s53, 9
    s_add_u32 s52, s52, s53
    s_add_u32 s52, s52, 139264
    v_add_u32 v255, s52, v255
    s_lshl_b32 s52, s54, 16
    v_lshlrev_b32 v4, 13, v2
    v_lshl_add_u32 v4, v3, 4, v4
    s_lshl_b32 s53, s21, 8
    s_add_u32 s52, s52, s53
    v_add_u32 v4, s52, v4
    v_lshlrev_b32 v5, 5, v3
    s_lshl_b32 s53, s21, 9
    v_add_u32 v5, s53, v5
    v_lshlrev_b32 v7, 5, v1
    s_movk_i32 s60, 0x1000
    s_mov_b32 s61, 0x8000
    s_mov_b32 s62, 0x9000
    s_add_u32 s57, s21, 1
    s_lshl_b32 s57, s57, 11
    s_cmp_lg_u32 s20, 0
    s_cbranch_scc1 S1_W
    s_cmp_eq_u32 s2, 0
    s_cbranch_scc0 S1_O
    v_lshlrev_b32 v13, 5, v1
    s_mov_b64 exec, 0xff
    s_mov_b32 s100, 0
S1_P:
    s_add_u32 s100, s100, 1
    s_and_b32 s101, s100, 1023
    s_cmp_eq_u32 s101, 0
    s_cbranch_scc1 S1_P_AT
    buffer_load_dword v14, v13, s[40:43], 0 offen sc1
    s_branch S1_P_WT
S1_P_AT:
    v_mov_b32 v14, 0
    buffer_atomic_add v14, v13, s[40:43], 0 offen sc0
S1_P_WT:
    s_waitcnt vmcnt(0)
    s_cmp_eq_u32 s24, 0
    s_cbranch_scc1 S1_R
    s_sub_u32 s24, s24, 1
    v_cmp_gt_u32 vcc, 32, v14
    s_cbranch_vccnz S1_P
S1_R:
    s_memrealtime s[52:53]
    s_mov_b64 exec, 0xffff
    v_lshlrev_b32 v13, 7, v1
    v_add_u32 v13, 1024, v13
    s_waitcnt lgkmcnt(0)
    s_or_b32 s52, s52, 1
    s_cmp_eq_u32 s52, s26
    s_cselect_b32 s53, 2, 0
    s_add_u32 s26, s52, s53
    v_mov_b32 v14, s26
    buffer_store_dword v14, v13, s[48:51], 0 offen sc1
    s_branch S1_X
S1_O:
    s_and_b32 s52, s2, 15
    s_lshl_b32 s52, s52, 7
    s_add_u32 s52, s52, 1024
    v_mov_b32 v13, s52
    s_mov_b64 exec, 1
    s_mov_b32 s100, 0
S1_Q:
    s_add_u32 s100, s100, 1
    s_and_b32 s101, s100, 1023
    s_cmp_eq_u32 s101, 0
    s_cbranch_scc1 S1_Q_AT
    buffer_load_dword v14, v13, s[48:51], 0 offen sc1
    s_branch S1_Q_WT
S1_Q_AT:
    v_mov_b32 v14, 0
    buffer_atomic_add v14, v13, s[48:51], 0 offen sc0
S1_Q_WT:
    s_waitcnt vmcnt(0)
    v_readfirstlane_b32 s27, v14
    s_cmp_eq_u32 s24, 0
    s_cbranch_scc1 S1_QX
    s_sub_u32 s24, s24, 1
    s_cmp_eq_u32 s27, s26
    s_cbranch_scc1 S1_Q
S1_QX:
    s_mov_b32 s26, s27
S1_X:
    s_mov_b64 exec, 1
    v_mov_b32 v12, 162880
    v_mov_b32 v13, s26
    ds_write_b32 v12, v13 offset:56
    v_mov_b32 v13, 1
    ds_write_b32 v12, v13 offset:12
    s_mov_b64 exec, -1
    s_branch S1_D
S1_W:
    v_mov_b32 v12, 162880
LW3:
    ds_read_b32 v14, v12 offset:12
    s_waitcnt lgkmcnt(0)
    v_readfirstlane_b32 s27, v14
    s_cmp_eq_u32 s24, 0
    s_cbranch_scc1 LW3_X
    s_sub_u32 s24, s24, 1
    s_cmp_lt_u32 s27, 1
    s_cbranch_scc1 LW3
LW3_X:
S1_D:
    buffer_load_dwordx4 v[16:19], v4, s[32:35], 0 offen offset:0 sc1
    buffer_load_dwordx4 v[20:23], v4, s[32:35], 0 offen offset:1024 sc1
    buffer_load_dwordx4 v[24:27], v4, s[32:35], 0 offen offset:2048 sc1
    buffer_load_dwordx4 v[28:31], v4, s[32:35], 0 offen offset:3072 sc1
    buffer_load_dwordx4 v[32:35], v4, s[32:35], s60 offen offset:0 sc1
    buffer_load_dwordx4 v[36:39], v4, s[32:35], s60 offen offset:1024 sc1
    buffer_load_dwordx4 v[40:43], v4, s[32:35], s60 offen offset:2048 sc1
    buffer_load_dwordx4 v[44:47], v4, s[32:35], s60 offen offset:3072 sc1
    buffer_load_dwordx4 v[144:147], v7, s[36:39], s57 offen sc1
    buffer_load_dwordx4 v[148:151], v7, s[36:39], s57 offen offset:16 sc1
    s_add_u32 s57, s57, 12288
    buffer_load_dwordx4 v[160:163], v7, s[36:39], s57 offen sc1
    buffer_load_dwordx4 v[164:167], v7, s[36:39], s57 offen offset:16 sc1
    s_mov_b32 s44, s6
    s_mov_b32 s45, s7
    s_mov_b32 s46, 65536
    s_mov_b32 s47, 0x20000
    s_bfe_u32 s52, s23, 0x10001
    s_lshl_b32 s53, s22, 1
    s_add_u32 s52, s52, s53
    s_lshl_b32 s27, s52, 7
    s_add_u32 s27, s27, 32768
    v_lshlrev_b32 v5, 2, v3
    s_mov_b32 s52, 0x05040100
    s_mov_b32 s53, 0x07060302
    s_cmp_lg_u32 s63, 0
    s_cbranch_scc1 P2_NOSA
    s_mov_b32 s58, 0
    buffer_load_dwordx4 v[104:107], v7, s[36:39], s58 offen sc1
    buffer_load_dwordx4 v[108:111], v7, s[36:39], s58 offen offset:16 sc1
    s_add_u32 s58, s58, 12288
    buffer_load_dwordx4 v[112:115], v7, s[36:39], s58 offen sc1
    buffer_load_dwordx4 v[116:119], v7, s[36:39], s58 offen offset:16 sc1
    s_waitcnt vmcnt(0)
    v_add_f32 v128, v104, v112
    v_add_f32 v129, v105, v113
    v_add_f32 v130, v106, v114
    v_add_f32 v131, v107, v115
    v_add_f32 v132, v108, v116
    v_add_f32 v133, v109, v117
    v_add_f32 v134, v110, v118
    v_add_f32 v135, v111, v119
    v_cvt_pk_bf16_f32 v136, v128, v129
    v_cvt_pk_bf16_f32 v137, v130, v131
    v_cvt_pk_bf16_f32 v138, v132, v133
    v_cvt_pk_bf16_f32 v139, v134, v135
    v_lshlrev_b32 v128, 16, v136
    v_and_b32 v129, 0xffff0000, v136
    v_lshlrev_b32 v130, 16, v137
    v_and_b32 v131, 0xffff0000, v137
    v_lshlrev_b32 v132, 16, v138
    v_and_b32 v133, 0xffff0000, v138
    v_lshlrev_b32 v134, 16, v139
    v_and_b32 v135, 0xffff0000, v139
    v_mul_f32 v128, 0x45000000, v128
    v_mul_f32 v129, 0x45000000, v129
    v_mul_f32 v130, 0x45000000, v130
    v_mul_f32 v131, 0x45000000, v131
    v_mul_f32 v132, 0x45000000, v132
    v_mul_f32 v133, 0x45000000, v133
    v_mul_f32 v134, 0x45000000, v134
    v_mul_f32 v135, 0x45000000, v135
    v_cvt_pk_bf16_f32 v136, v128, v129
    v_cvt_pk_bf16_f32 v137, v130, v131
    v_cvt_pk_bf16_f32 v138, v132, v133
    v_cvt_pk_bf16_f32 v139, v134, v135
    ds_write_b128 v254, v[136:139]
    v_add_u32 v8, 8192, v249
    s_waitcnt lgkmcnt(0)
    ds_read_b64_tr_b16 v[140:141], v8
    ds_read_b64_tr_b16 v[142:143], v8 offset:128
    s_waitcnt lgkmcnt(0)
    v_mfma_f32_16x16x32_bf16 v[96:99], v[140:143], v[192:195], 0
    v_mfma_f32_16x16x32_bf16 v[104:107], v[140:143], v[208:211], 0
    v_mfma_f32_16x16x32_bf16 v[100:103], v[140:143], v[196:199], 0
    v_mfma_f32_16x16x32_bf16 v[108:111], v[140:143], v[212:215], 0
    s_nop 4
    v_pk_mul_f32 v[120:121], v[96:97], v[216:217]
    v_pk_mul_f32 v[128:129], v[104:105], v[216:217]
    v_pk_mul_f32 v[122:123], v[98:99], v[218:219]
    v_pk_mul_f32 v[130:131], v[106:107], v[218:219]
    v_pk_fma_f32 v[120:121], v[104:105], v[224:225], v[120:121]
    v_pk_fma_f32 v[128:129], v[96:97], v[224:225], v[128:129] neg_lo:[1,0,0] neg_hi:[1,0,0]
    v_pk_fma_f32 v[122:123], v[106:107], v[226:227], v[122:123]
    v_pk_fma_f32 v[130:131], v[98:99], v[226:227], v[130:131] neg_lo:[1,0,0] neg_hi:[1,0,0]
    v_cvt_pk_bf16_f32 v112, v120, v121
    v_cvt_pk_bf16_f32 v113, v122, v123
    v_cvt_pk_bf16_f32 v114, v128, v129
    v_cvt_pk_bf16_f32 v115, v130, v131
    v_pk_mul_f32 v[124:125], v[100:101], v[220:221]
    v_pk_mul_f32 v[132:133], v[108:109], v[220:221]
    v_pk_mul_f32 v[126:127], v[102:103], v[222:223]
    v_pk_mul_f32 v[134:135], v[110:111], v[222:223]
    v_pk_fma_f32 v[124:125], v[108:109], v[228:229], v[124:125]
    v_pk_fma_f32 v[132:133], v[100:101], v[228:229], v[132:133] neg_lo:[1,0,0] neg_hi:[1,0,0]
    v_pk_fma_f32 v[126:127], v[110:111], v[230:231], v[126:127]
    v_pk_fma_f32 v[134:135], v[102:103], v[230:231], v[134:135] neg_lo:[1,0,0] neg_hi:[1,0,0]
    v_cvt_pk_bf16_f32 v116, v124, v125
    v_cvt_pk_bf16_f32 v117, v126, v127
    v_cvt_pk_bf16_f32 v118, v132, v133
    v_cvt_pk_bf16_f32 v119, v134, v135
    v_mfma_f32_16x16x32_bf16 v[240:243], v[112:115], v[232:235], 0
    s_nop 0
    v_mfma_f32_16x16x32_bf16 v[244:247], v[116:119], v[232:235], 0
P2_NOSA:
    s_waitcnt vmcnt(4)
    v_perm_b32 v80, v20, v16, s52
    v_perm_b32 v81, v28, v24, s52
    v_perm_b32 v82, v36, v32, s52
    buffer_load_dwordx4 v[48:51], v4, s[32:35], s61 offen offset:0 sc1
    v_perm_b32 v83, v44, v40, s52
    v_perm_b32 v84, v20, v16, s53
    v_perm_b32 v85, v28, v24, s53
    buffer_load_dwordx4 v[52:55], v4, s[32:35], s61 offen offset:1024 sc1
    v_perm_b32 v86, v36, v32, s53
    v_perm_b32 v87, v44, v40, s53
    v_perm_b32 v88, v21, v17, s52
    buffer_load_dwordx4 v[56:59], v4, s[32:35], s61 offen offset:2048 sc1
    v_perm_b32 v89, v29, v25, s52
    v_perm_b32 v90, v37, v33, s52
    v_perm_b32 v91, v45, v41, s52
    buffer_load_dwordx4 v[60:63], v4, s[32:35], s61 offen offset:3072 sc1
    v_perm_b32 v92, v21, v17, s53
    v_perm_b32 v93, v29, v25, s53
    v_perm_b32 v94, v37, v33, s53
    buffer_load_dwordx4 v[64:67], v4, s[32:35], s62 offen offset:0 sc1
    v_perm_b32 v95, v45, v41, s53
    v_perm_b32 v96, v22, v18, s52
    v_perm_b32 v97, v30, v26, s52
    buffer_load_dwordx4 v[68:71], v4, s[32:35], s62 offen offset:1024 sc1
    v_perm_b32 v98, v38, v34, s52
    v_perm_b32 v99, v46, v42, s52
    v_perm_b32 v100, v22, v18, s53
    buffer_load_dwordx4 v[72:75], v4, s[32:35], s62 offen offset:2048 sc1
    v_perm_b32 v101, v30, v26, s53
    v_perm_b32 v102, v38, v34, s53
    v_perm_b32 v103, v46, v42, s53
    buffer_load_dwordx4 v[76:79], v4, s[32:35], s62 offen offset:3072 sc1
    v_perm_b32 v104, v23, v19, s52
    v_perm_b32 v105, v31, v27, s52
    v_perm_b32 v106, v39, v35, s52
    buffer_load_dword v15, v5, s[44:47], s27 offen sc1
    v_perm_b32 v107, v47, v43, s52
    v_perm_b32 v108, v23, v19, s53
    v_perm_b32 v109, v31, v27, s53
    v_perm_b32 v110, v39, v35, s53
    v_perm_b32 v111, v47, v43, s53
    v_mfma_f32_16x16x32_bf16 v[16:19], v[184:187], v[80:83], 0
    v_mfma_f32_16x16x32_bf16 v[20:23], v[184:187], v[84:87], 0
    v_mfma_f32_16x16x32_bf16 v[24:27], v[184:187], v[88:91], 0
    v_mfma_f32_16x16x32_bf16 v[28:31], v[184:187], v[92:95], 0
    v_mfma_f32_16x16x32_bf16 v[32:35], v[184:187], v[96:99], 0
    v_mfma_f32_16x16x32_bf16 v[36:39], v[184:187], v[100:103], 0
    v_mfma_f32_16x16x32_bf16 v[40:43], v[184:187], v[104:107], 0
    v_mfma_f32_16x16x32_bf16 v[44:47], v[184:187], v[108:111], 0
    s_waitcnt vmcnt(9)
    v_pk_add_f32 v[144:145], v[144:145], v[160:161]
    v_pk_add_f32 v[146:147], v[146:147], v[162:163]
    v_pk_add_f32 v[148:149], v[148:149], v[164:165]
    v_pk_add_f32 v[150:151], v[150:151], v[166:167]
    v_cvt_pk_bf16_f32 v8, v144, v145
    v_cvt_pk_bf16_f32 v9, v146, v147
    v_cvt_pk_bf16_f32 v10, v148, v149
    v_cvt_pk_bf16_f32 v11, v150, v151
    s_add_u32 s58, s21, 1
    s_and_b32 s58, s58, 2
    s_cmp_lg_u32 s58, 0
    s_cbranch_scc1 P2_NOK2
    v_lshlrev_b32 v144, 16, v8
    v_and_b32 v145, 0xffff0000, v8
    v_lshlrev_b32 v146, 16, v9
    v_and_b32 v147, 0xffff0000, v9
    v_lshlrev_b32 v148, 16, v10
    v_and_b32 v149, 0xffff0000, v10
    v_lshlrev_b32 v150, 16, v11
    v_and_b32 v151, 0xffff0000, v11
    v_add_f32 v144, 1.0, v144
    v_add_f32 v145, 1.0, v145
    v_add_f32 v146, 1.0, v146
    v_add_f32 v147, 1.0, v147
    v_add_f32 v148, 1.0, v148
    v_add_f32 v149, 1.0, v149
    v_add_f32 v150, 1.0, v150
    v_add_f32 v151, 1.0, v151
    v_cvt_pk_bf16_f32 v8, v144, v145
    v_cvt_pk_bf16_f32 v9, v146, v147
    v_cvt_pk_bf16_f32 v10, v148, v149
    v_cvt_pk_bf16_f32 v11, v150, v151
P2_NOK2:
    s_lshl_b32 s57, s21, 10
    s_add_u32 s57, s57, 158784
    v_add_u32 v12, s57, v6
    ds_write_b128 v12, v[8:11]
    v_mov_b32 v12, 162880
    v_mov_b32 v13, 1
    s_mov_b64 exec, 1
    ds_add_u32 v12, v13 offset:84
    s_mov_b64 exec, -1
    s_waitcnt vmcnt(1)
    v_perm_b32 v112, v52, v48, s52
    v_perm_b32 v113, v60, v56, s52
    v_perm_b32 v114, v68, v64, s52
    v_perm_b32 v115, v76, v72, s52
    v_perm_b32 v116, v52, v48, s53
    v_perm_b32 v117, v60, v56, s53
    v_perm_b32 v118, v68, v64, s53
    v_perm_b32 v119, v76, v72, s53
    v_perm_b32 v120, v53, v49, s52
    v_perm_b32 v121, v61, v57, s52
    v_perm_b32 v122, v69, v65, s52
    v_perm_b32 v123, v77, v73, s52
    v_perm_b32 v124, v53, v49, s53
    v_perm_b32 v125, v61, v57, s53
    v_perm_b32 v126, v69, v65, s53
    v_perm_b32 v127, v77, v73, s53
    v_perm_b32 v128, v54, v50, s52
    v_perm_b32 v129, v62, v58, s52
    v_perm_b32 v130, v70, v66, s52
    v_perm_b32 v131, v78, v74, s52
    v_perm_b32 v132, v54, v50, s53
    v_perm_b32 v133, v62, v58, s53
    v_perm_b32 v134, v70, v66, s53
    v_perm_b32 v135, v78, v74, s53
    v_perm_b32 v136, v55, v51, s52
    v_perm_b32 v137, v63, v59, s52
    v_perm_b32 v138, v71, v67, s52
    v_perm_b32 v139, v79, v75, s52
    v_perm_b32 v140, v55, v51, s53
    v_perm_b32 v141, v63, v59, s53
    v_perm_b32 v142, v71, v67, s53
    v_perm_b32 v143, v79, v75, s53
    v_mfma_f32_16x16x32_bf16 v[16:19], v[188:191], v[112:115], v[16:19]
    v_mfma_f32_16x16x32_bf16 v[20:23], v[188:191], v[116:119], v[20:23]
    v_mfma_f32_16x16x32_bf16 v[24:27], v[188:191], v[120:123], v[24:27]
    v_mfma_f32_16x16x32_bf16 v[28:31], v[188:191], v[124:127], v[28:31]
    v_mfma_f32_16x16x32_bf16 v[32:35], v[188:191], v[128:131], v[32:35]
    v_mfma_f32_16x16x32_bf16 v[36:39], v[188:191], v[132:135], v[36:39]
    v_mfma_f32_16x16x32_bf16 v[40:43], v[188:191], v[136:139], v[40:43]
    v_mfma_f32_16x16x32_bf16 v[44:47], v[188:191], v[140:143], v[44:47]
LW4:
    ds_read_b32 v14, v12 offset:84
    s_waitcnt lgkmcnt(0)
    v_readfirstlane_b32 s27, v14
    s_cmp_eq_u32 s24, 0
    s_cbranch_scc1 LW4_X
    s_sub_u32 s24, s24, 1
    s_cmp_lt_u32 s27, 4
    s_cbranch_scc1 LW4
LW4_X:
    v_lshlrev_b32 v14, 4, v3
    s_lshl_b32 s57, s21, 8
    s_add_u32 s57, s57, 158784
    v_add_u32 v14, s57, v14
    ds_read_b128 v[8:11], v14
    s_waitcnt vmcnt(0)
    s_getreg_b32 s58, hwreg(HW_REG_XCC_ID)
    s_and_b32 s58, s58, 15
    v_cmp_ne_u32 vcc, s58, v15
    s_cmp_eq_u64 vcc, 0
    s_cselect_b32 s25, 1, 0
    ds_read_b32 v15, v12 offset:56
    s_waitcnt lgkmcnt(1)
    v_lshlrev_b32 v144, 16, v8
    v_and_b32 v145, 0xffff0000, v8
    v_lshlrev_b32 v146, 16, v9
    v_and_b32 v147, 0xffff0000, v9
    v_lshlrev_b32 v148, 16, v10
    v_and_b32 v149, 0xffff0000, v10
    v_lshlrev_b32 v150, 16, v11
    v_and_b32 v151, 0xffff0000, v11
    s_mov_b32 exec_hi, 0
    v_pk_mul_f32 v[16:17], v[16:17], v[144:145] op_sel:[0,0] op_sel_hi:[1,0]
    v_pk_mul_f32 v[18:19], v[18:19], v[144:145] op_sel:[0,0] op_sel_hi:[1,0]
    v_pk_mul_f32 v[20:21], v[20:21], v[144:145] op_sel:[0,1] op_sel_hi:[1,1]
    v_pk_mul_f32 v[22:23], v[22:23], v[144:145] op_sel:[0,1] op_sel_hi:[1,1]
    v_pk_mul_f32 v[24:25], v[24:25], v[146:147] op_sel:[0,0] op_sel_hi:[1,0]
    v_pk_mul_f32 v[26:27], v[26:27], v[146:147] op_sel:[0,0] op_sel_hi:[1,0]
    v_pk_mul_f32 v[28:29], v[28:29], v[146:147] op_sel:[0,1] op_sel_hi:[1,1]
    v_pk_mul_f32 v[30:31], v[30:31], v[146:147] op_sel:[0,1] op_sel_hi:[1,1]
    v_pk_mul_f32 v[32:33], v[32:33], v[148:149] op_sel:[0,0] op_sel_hi:[1,0]
    v_pk_mul_f32 v[34:35], v[34:35], v[148:149] op_sel:[0,0] op_sel_hi:[1,0]
    v_pk_mul_f32 v[36:37], v[36:37], v[148:149] op_sel:[0,1] op_sel_hi:[1,1]
    v_pk_mul_f32 v[38:39], v[38:39], v[148:149] op_sel:[0,1] op_sel_hi:[1,1]
    v_pk_mul_f32 v[40:41], v[40:41], v[150:151] op_sel:[0,0] op_sel_hi:[1,0]
    v_pk_mul_f32 v[42:43], v[42:43], v[150:151] op_sel:[0,0] op_sel_hi:[1,0]
    v_pk_mul_f32 v[44:45], v[44:45], v[150:151] op_sel:[0,1] op_sel_hi:[1,1]
    v_pk_mul_f32 v[46:47], v[46:47], v[150:151] op_sel:[0,1] op_sel_hi:[1,1]
    v_cvt_pk_bf16_f32 v48, v16, v20
    v_cvt_pk_bf16_f32 v49, v24, v28
    v_cvt_pk_bf16_f32 v50, v32, v36
    v_cvt_pk_bf16_f32 v51, v40, v44
    ds_write_b128 v248, v[48:51] offset:0
    v_cvt_pk_bf16_f32 v52, v17, v21
    v_cvt_pk_bf16_f32 v53, v25, v29
    v_cvt_pk_bf16_f32 v54, v33, v37
    v_cvt_pk_bf16_f32 v55, v41, v45
    ds_write_b128 v248, v[52:55] offset:1024
    v_cvt_pk_bf16_f32 v56, v18, v22
    v_cvt_pk_bf16_f32 v57, v26, v30
    v_cvt_pk_bf16_f32 v58, v34, v38
    v_cvt_pk_bf16_f32 v59, v42, v46
    ds_write_b128 v248, v[56:59] offset:2048
    v_cvt_pk_bf16_f32 v60, v19, v23
    v_cvt_pk_bf16_f32 v61, v27, v31
    v_cvt_pk_bf16_f32 v62, v35, v39
    v_cvt_pk_bf16_f32 v63, v43, v47
    ds_write_b128 v248, v[60:63] offset:3072
    s_mov_b64 exec, -1
    v_mov_b32 v8, 162880
    v_mov_b32 v9, 1
    s_mov_b64 exec, 1
    ds_add_u32 v8, v9 offset:16
    s_mov_b64 exec, -1
LW5:
    ds_read_b32 v10, v8 offset:16
    s_waitcnt lgkmcnt(0)
    v_readfirstlane_b32 s27, v10
    s_cmp_eq_u32 s24, 0
    s_cbranch_scc1 LW5_X
    s_sub_u32 s24, s24, 1
    s_cmp_lt_u32 s27, 4
    s_cbranch_scc1 LW5
LW5_X:
    v_readfirstlane_b32 s26, v15
    ds_read_b64_tr_b16 v[80:81], v249
    ds_read_b64_tr_b16 v[82:83], v249 offset:128
    ds_read_b64_tr_b16 v[84:85], v249 offset:1024
    ds_read_b64_tr_b16 v[86:87], v249 offset:1152
    v_add_u32 v8, 158784, v6
    ds_read_b128 v[160:163], v8 offset:1024
    ds_read_b128 v[164:167], v8 offset:2048
    ds_read_b128 v[168:171], v8 offset:3072
    v_lshlrev_b32 v88, 16, v152
    v_and_b32 v89, 0xffff0000, v152
    v_lshlrev_b32 v90, 16, v153
    v_and_b32 v91, 0xffff0000, v153
    v_lshlrev_b32 v92, 16, v154
    v_and_b32 v93, 0xffff0000, v154
    v_lshlrev_b32 v94, 16, v155
    v_and_b32 v95, 0xffff0000, v155
    v_lshlrev_b32 v32, 16, v156
    v_and_b32 v33, 0xffff0000, v156
    v_lshlrev_b32 v34, 16, v157
    v_and_b32 v35, 0xffff0000, v157
    v_lshlrev_b32 v36, 16, v158
    v_and_b32 v37, 0xffff0000, v158
    v_lshlrev_b32 v38, 16, v159
    v_and_b32 v39, 0xffff0000, v159
    s_waitcnt lgkmcnt(3)
    v_mfma_f32_16x16x32_bf16 v[96:99], v[80:83], v[192:195], 0
    v_mfma_f32_16x16x32_bf16 v[104:107], v[80:83], v[208:211], 0
    v_mfma_f32_16x16x32_bf16 v[100:103], v[80:83], v[196:199], 0
    v_mfma_f32_16x16x32_bf16 v[108:111], v[80:83], v[212:215], 0
    v_mfma_f32_16x16x32_bf16 v[96:99], v[84:87], v[200:203], v[96:99]
    v_mfma_f32_16x16x32_bf16 v[104:107], v[84:87], v[192:195], v[104:107]
    v_mfma_f32_16x16x32_bf16 v[100:103], v[84:87], v[204:207], v[100:103]
    v_mfma_f32_16x16x32_bf16 v[108:111], v[84:87], v[196:199], v[108:111]
    s_nop 4
    v_pk_mul_f32 v[120:121], v[96:97], v[216:217]
    v_pk_mul_f32 v[128:129], v[104:105], v[216:217]
    v_pk_mul_f32 v[122:123], v[98:99], v[218:219]
    v_pk_mul_f32 v[130:131], v[106:107], v[218:219]
    v_pk_fma_f32 v[120:121], v[104:105], v[224:225], v[120:121]
    v_pk_fma_f32 v[128:129], v[96:97], v[224:225], v[128:129] neg_lo:[1,0,0] neg_hi:[1,0,0]
    v_pk_fma_f32 v[122:123], v[106:107], v[226:227], v[122:123]
    v_pk_fma_f32 v[130:131], v[98:99], v[226:227], v[130:131] neg_lo:[1,0,0] neg_hi:[1,0,0]
    v_cvt_pk_bf16_f32 v112, v120, v121
    v_cvt_pk_bf16_f32 v113, v122, v123
    v_cvt_pk_bf16_f32 v114, v128, v129
    v_cvt_pk_bf16_f32 v115, v130, v131
    v_pk_mul_f32 v[124:125], v[100:101], v[220:221]
    v_pk_mul_f32 v[132:133], v[108:109], v[220:221]
    v_pk_mul_f32 v[126:127], v[102:103], v[222:223]
    v_pk_mul_f32 v[134:135], v[110:111], v[222:223]
    v_pk_fma_f32 v[124:125], v[108:109], v[228:229], v[124:125]
    v_pk_fma_f32 v[132:133], v[100:101], v[228:229], v[132:133] neg_lo:[1,0,0] neg_hi:[1,0,0]
    v_pk_fma_f32 v[126:127], v[110:111], v[230:231], v[126:127]
    v_pk_fma_f32 v[134:135], v[102:103], v[230:231], v[134:135] neg_lo:[1,0,0] neg_hi:[1,0,0]
    v_cvt_pk_bf16_f32 v116, v124, v125
    v_cvt_pk_bf16_f32 v117, v126, v127
    v_cvt_pk_bf16_f32 v118, v132, v133
    v_cvt_pk_bf16_f32 v119, v134, v135
    v_mfma_f32_16x16x32_bf16 v[16:19], v[112:115], v[232:235], 0
    s_nop 0
    v_mfma_f32_16x16x32_bf16 v[20:23], v[116:119], v[232:235], 0
    s_waitcnt lgkmcnt(0)
    s_cmp_lg_u32 s63, 0
    s_cbranch_scc1 P2_REG
    v_mfma_f32_16x16x32_bf16 v[24:27], v[112:115], v[236:239], 0
    v_mfma_f32_16x16x32_bf16 v[28:31], v[116:119], v[236:239], 0
    v_lshlrev_b32 v144, 16, v160
    v_and_b32 v145, 0xffff0000, v160
    v_lshlrev_b32 v146, 16, v161
    v_and_b32 v147, 0xffff0000, v161
    v_lshlrev_b32 v148, 16, v162
    v_and_b32 v149, 0xffff0000, v162
    v_lshlrev_b32 v150, 16, v163
    v_and_b32 v151, 0xffff0000, v163
    v_add_f32 v16, v16, v240
    v_add_f32 v17, v17, v241
    v_add_f32 v18, v18, v242
    v_add_f32 v19, v19, v243
    v_add_f32 v20, v20, v244
    v_add_f32 v21, v21, v245
    v_add_f32 v22, v22, v246
    v_add_f32 v23, v23, v247
    ds_write_b128 v250, v[16:19] offset:0
    ds_write_b128 v250, v[24:27] offset:2432
    ds_write_b128 v250, v[20:23] offset:64
    ds_write_b128 v250, v[28:31] offset:2496
    s_waitcnt lgkmcnt(0)
    ds_read_b128 v[40:43], v251 offset:0
    ds_read_b128 v[44:47], v251 offset:16
    ds_read_b128 v[48:51], v252 offset:0
    ds_read_b128 v[52:55], v252 offset:16
    ds_read_b32 v56, v253 offset:0
    s_waitcnt lgkmcnt(0)
    v_add_f32 v64, v40, v56
    v_add_f32 v65, v41, v55
    v_add_f32 v66, v42, v54
    v_add_f32 v67, v43, v53
    v_add_f32 v68, v44, v52
    v_add_f32 v69, v45, v51
    v_add_f32 v70, v46, v50
    v_add_f32 v71, v47, v49
    v_mul_f32 v64, 0.5, v64
    v_mul_f32 v65, 0.5, v65
    v_mul_f32 v66, 0.5, v66
    v_mul_f32 v67, 0.5, v67
    v_mul_f32 v68, 0.5, v68
    v_mul_f32 v69, 0.5, v69
    v_mul_f32 v70, 0.5, v70
    v_mul_f32 v71, 0.5, v71
    ds_read_b128 v[40:43], v251 offset:2432
    ds_read_b128 v[44:47], v251 offset:2448
    ds_read_b128 v[48:51], v252 offset:2432
    ds_read_b128 v[52:55], v252 offset:2448
    ds_read_b32 v56, v253 offset:2432
    s_waitcnt lgkmcnt(0)
    v_add_f32 v72, v40, v56
    v_add_f32 v73, v41, v55
    v_add_f32 v74, v42, v54
    v_add_f32 v75, v43, v53
    v_add_f32 v76, v44, v52
    v_add_f32 v77, v45, v51
    v_add_f32 v78, v46, v50
    v_add_f32 v79, v47, v49
    v_mul_f32 v72, 0.5, v72
    v_mul_f32 v73, 0.5, v73
    v_mul_f32 v74, 0.5, v74
    v_mul_f32 v75, 0.5, v75
    v_mul_f32 v76, 0.5, v76
    v_mul_f32 v77, 0.5, v77
    v_mul_f32 v78, 0.5, v78
    v_mul_f32 v79, 0.5, v79
    v_fma_f32 v32, v144, v72, v32
    v_fma_f32 v33, v145, v73, v33
    v_fma_f32 v34, v146, v74, v34
    v_fma_f32 v35, v147, v75, v35
    v_fma_f32 v36, v148, v76, v36
    v_fma_f32 v37, v149, v77, v37
    v_fma_f32 v38, v150, v78, v38
    v_fma_f32 v39, v151, v79, v39
    v_lshlrev_b32 v176, 16, v168
    v_and_b32 v177, 0xffff0000, v168
    v_lshlrev_b32 v178, 16, v169
    v_and_b32 v179, 0xffff0000, v169
    v_lshlrev_b32 v180, 16, v170
    v_and_b32 v181, 0xffff0000, v170
    v_lshlrev_b32 v182, 16, v171
    v_and_b32 v183, 0xffff0000, v171
    v_lshlrev_b32 v136, 16, v164
    v_and_b32 v137, 0xffff0000, v164
    v_lshlrev_b32 v138, 16, v165
    v_and_b32 v139, 0xffff0000, v165
    v_lshlrev_b32 v140, 16, v166
    v_and_b32 v141, 0xffff0000, v166
    v_lshlrev_b32 v142, 16, v167
    v_and_b32 v143, 0xffff0000, v167
    s_branch P2_EPI
P2_REG:
    ds_write_b128 v250, v[16:19] offset:0
    ds_write_b128 v250, v[20:23] offset:64
    v_lshlrev_b32 v144, 16, v160
    v_and_b32 v145, 0xffff0000, v160
    v_lshlrev_b32 v146, 16, v161
    v_and_b32 v147, 0xffff0000, v161
    v_lshlrev_b32 v148, 16, v162
    v_and_b32 v149, 0xffff0000, v162
    v_lshlrev_b32 v150, 16, v163
    v_and_b32 v151, 0xffff0000, v163
    s_waitcnt lgkmcnt(0)
    ds_read_b128 v[64:67], v251
    ds_read_b128 v[68:71], v251 offset:16
    ds_read_b128 v[48:51], v252
    ds_read_b128 v[52:55], v252 offset:16
    ds_read_b32 v56, v253
    v_lshlrev_b32 v176, 16, v168
    v_and_b32 v177, 0xffff0000, v168
    v_lshlrev_b32 v178, 16, v169
    v_and_b32 v179, 0xffff0000, v169
    v_lshlrev_b32 v180, 16, v170
    v_and_b32 v181, 0xffff0000, v170
    v_lshlrev_b32 v182, 16, v171
    v_and_b32 v183, 0xffff0000, v171
    v_lshlrev_b32 v136, 16, v164
    v_and_b32 v137, 0xffff0000, v164
    v_lshlrev_b32 v138, 16, v165
    v_and_b32 v139, 0xffff0000, v165
    v_lshlrev_b32 v140, 16, v166
    v_and_b32 v141, 0xffff0000, v166
    v_lshlrev_b32 v142, 16, v167
    v_and_b32 v143, 0xffff0000, v167
    s_waitcnt lgkmcnt(0)
    v_fma_f32 v32, v144, v56, v32
    v_fma_f32 v33, v145, v55, v33
    v_fma_f32 v34, v146, v54, v34
    v_fma_f32 v35, v147, v53, v35
    v_fma_f32 v36, v148, v52, v36
    v_fma_f32 v37, v149, v51, v37
    v_fma_f32 v38, v150, v50, v38
    v_fma_f32 v39, v151, v49, v39
P2_EPI:
    v_pk_fma_f32 v[88:89], v[144:145], v[64:65], v[88:89]
    v_pk_fma_f32 v[90:91], v[146:147], v[66:67], v[90:91]
    v_pk_fma_f32 v[92:93], v[148:149], v[68:69], v[92:93]
    v_pk_fma_f32 v[94:95], v[150:151], v[70:71], v[94:95]
    v_cvt_pk_bf16_f32 v80, v88, v89
    v_cvt_pk_bf16_f32 v81, v90, v91
    v_cvt_pk_bf16_f32 v82, v92, v93
    v_cvt_pk_bf16_f32 v83, v94, v95
    v_cvt_pk_bf16_f32 v84, v32, v33
    v_cvt_pk_bf16_f32 v85, v34, v35
    v_cvt_pk_bf16_f32 v86, v36, v37
    v_cvt_pk_bf16_f32 v87, v38, v39
    s_mov_b32 s52, 0x3f803f80
    v_dot2_f32_bf16 v104, v80, s52, 0
    v_dot2_f32_bf16 v105, v80, v80, 0
    v_dot2_f32_bf16 v106, v84, s52, 0
    v_dot2_f32_bf16 v107, v84, v84, 0
    v_dot2_f32_bf16 v104, v81, s52, v104
    v_dot2_f32_bf16 v105, v81, v81, v105
    v_dot2_f32_bf16 v106, v85, s52, v106
    v_dot2_f32_bf16 v107, v85, v85, v107
    v_dot2_f32_bf16 v104, v82, s52, v104
    v_dot2_f32_bf16 v105, v82, v82, v105
    v_dot2_f32_bf16 v106, v86, s52, v106
    v_dot2_f32_bf16 v107, v86, v86, v107
    v_dot2_f32_bf16 v104, v83, s52, v104
    v_dot2_f32_bf16 v105, v83, v83, v105
    v_dot2_f32_bf16 v106, v87, s52, v106
    v_dot2_f32_bf16 v107, v87, v87, v107
    ds_write_b128 v254, v[80:83]
    ds_write_b128 v254, v[84:87] offset:1088
    v_add_f32_dpp v104, v104, v104 quad_perm:[1,0,3,2] row_mask:0xf bank_mask:0xf
    v_add_f32_dpp v105, v105, v105 quad_perm:[1,0,3,2] row_mask:0xf bank_mask:0xf
    v_add_f32_dpp v106, v106, v106 quad_perm:[1,0,3,2] row_mask:0xf bank_mask:0xf
    v_add_f32_dpp v107, v107, v107 quad_perm:[1,0,3,2] row_mask:0xf bank_mask:0xf
    v_lshlrev_b32 v88, 16, v80
    v_and_b32 v89, 0xffff0000, v80
    v_lshlrev_b32 v90, 16, v81
    v_and_b32 v91, 0xffff0000, v81
    v_add_f32_dpp v104, v104, v104 quad_perm:[2,3,0,1] row_mask:0xf bank_mask:0xf
    v_add_f32_dpp v105, v105, v105 quad_perm:[2,3,0,1] row_mask:0xf bank_mask:0xf
    v_add_f32_dpp v106, v106, v106 quad_perm:[2,3,0,1] row_mask:0xf bank_mask:0xf
    v_add_f32_dpp v107, v107, v107 quad_perm:[2,3,0,1] row_mask:0xf bank_mask:0xf
    v_lshlrev_b32 v92, 16, v82
    v_and_b32 v93, 0xffff0000, v82
    v_lshlrev_b32 v94, 16, v83
    v_and_b32 v95, 0xffff0000, v83
    v_add_f32_dpp v104, v104, v104 row_half_mirror row_mask:0xf bank_mask:0xf
    v_add_f32_dpp v105, v105, v105 row_half_mirror row_mask:0xf bank_mask:0xf
    v_add_f32_dpp v106, v106, v106 row_half_mirror row_mask:0xf bank_mask:0xf
    v_add_f32_dpp v107, v107, v107 row_half_mirror row_mask:0xf bank_mask:0xf
    v_lshlrev_b32 v32, 16, v84
    v_and_b32 v33, 0xffff0000, v84
    v_lshlrev_b32 v34, 16, v85
    v_and_b32 v35, 0xffff0000, v85
    v_add_f32_dpp v104, v104, v104 row_mirror row_mask:0xf bank_mask:0xf
    v_add_f32_dpp v105, v105, v105 row_mirror row_mask:0xf bank_mask:0xf
    v_add_f32_dpp v106, v106, v106 row_mirror row_mask:0xf bank_mask:0xf
    v_add_f32_dpp v107, v107, v107 row_mirror row_mask:0xf bank_mask:0xf
    v_lshlrev_b32 v36, 16, v86
    v_and_b32 v37, 0xffff0000, v86
    v_lshlrev_b32 v38, 16, v87
    v_and_b32 v39, 0xffff0000, v87
    v_mov_b32 v108, v104
    v_mov_b32 v109, v105
    v_mov_b32 v110, v106
    v_mov_b32 v111, v107
    v_permlane16_swap_b32 v104, v108
    v_permlane16_swap_b32 v105, v109
    v_permlane16_swap_b32 v106, v110
    v_permlane16_swap_b32 v107, v111
    v_add_f32 v104, v104, v108
    v_add_f32 v105, v105, v109
    v_add_f32 v106, v106, v110
    v_add_f32 v107, v107, v111
    v_mov_b32 v108, v104
    v_mov_b32 v109, v105
    v_mov_b32 v110, v106
    v_mov_b32 v111, v107
    v_permlane32_swap_b32 v104, v108
    v_permlane32_swap_b32 v105, v109
    v_permlane32_swap_b32 v106, v110
    v_permlane32_swap_b32 v107, v111
    v_add_f32 v104, v104, v108
    v_add_f32 v105, v105, v109
    v_add_f32 v106, v106, v110
    v_add_f32 v107, v107, v111
    v_mul_f32 v104, 0x3b000000, v104
    v_mul_f32 v105, 0x3b000000, v105
    v_mul_f32 v106, 0x3b000000, v106
    v_mul_f32 v107, 0x3b000000, v107
    v_fma_f32 v105, -v104, v104, v105
    v_fma_f32 v107, -v106, v106, v107
    v_max_f32 v105, 0, v105
    v_max_f32 v107, 0, v107
    v_add_f32 v105, 0x3727c5ac, v105
    v_add_f32 v107, 0x3727c5ac, v107
    v_rsq_f32 v105, v105
    v_rsq_f32 v107, v107
    v_pk_add_f32 v[88:89], v[88:89], v[104:105] op_sel_hi:[1,0] neg_lo:[0,1] neg_hi:[0,1]
    v_pk_add_f32 v[90:91], v[90:91], v[104:105] op_sel_hi:[1,0] neg_lo:[0,1] neg_hi:[0,1]
    v_pk_add_f32 v[92:93], v[92:93], v[104:105] op_sel_hi:[1,0] neg_lo:[0,1] neg_hi:[0,1]
    v_pk_add_f32 v[94:95], v[94:95], v[104:105] op_sel_hi:[1,0] neg_lo:[0,1] neg_hi:[0,1]
    v_pk_add_f32 v[32:33], v[32:33], v[106:107] op_sel_hi:[1,0] neg_lo:[0,1] neg_hi:[0,1]
    v_pk_add_f32 v[34:35], v[34:35], v[106:107] op_sel_hi:[1,0] neg_lo:[0,1] neg_hi:[0,1]
    v_pk_add_f32 v[36:37], v[36:37], v[106:107] op_sel_hi:[1,0] neg_lo:[0,1] neg_hi:[0,1]
    v_pk_add_f32 v[38:39], v[38:39], v[106:107] op_sel_hi:[1,0] neg_lo:[0,1] neg_hi:[0,1]
    v_pk_mul_f32 v[88:89], v[88:89], v[104:105] op_sel:[0,1] op_sel_hi:[1,1]
    v_pk_mul_f32 v[90:91], v[90:91], v[104:105] op_sel:[0,1] op_sel_hi:[1,1]
    v_pk_mul_f32 v[92:93], v[92:93], v[104:105] op_sel:[0,1] op_sel_hi:[1,1]
    v_pk_mul_f32 v[94:95], v[94:95], v[104:105] op_sel:[0,1] op_sel_hi:[1,1]
    v_pk_fma_f32 v[88:89], v[88:89], v[176:177], v[136:137]
    v_pk_fma_f32 v[90:91], v[90:91], v[178:179], v[138:139]
    v_pk_fma_f32 v[92:93], v[92:93], v[180:181], v[140:141]
    v_pk_fma_f32 v[94:95], v[94:95], v[182:183], v[142:143]
    v_cvt_pk_bf16_f32 v112, v88, v89
    v_cvt_pk_bf16_f32 v113, v90, v91
    v_cvt_pk_bf16_f32 v114, v92, v93
    v_cvt_pk_bf16_f32 v115, v94, v95
    ds_write_b128 v254, v[112:115] offset:2176
    v_pk_mul_f32 v[32:33], v[32:33], v[106:107] op_sel:[0,1] op_sel_hi:[1,1]
    v_pk_mul_f32 v[34:35], v[34:35], v[106:107] op_sel:[0,1] op_sel_hi:[1,1]
    v_pk_mul_f32 v[36:37], v[36:37], v[106:107] op_sel:[0,1] op_sel_hi:[1,1]
    v_pk_mul_f32 v[38:39], v[38:39], v[106:107] op_sel:[0,1] op_sel_hi:[1,1]
    v_pk_fma_f32 v[32:33], v[32:33], v[176:177], v[136:137]
    v_pk_fma_f32 v[34:35], v[34:35], v[178:179], v[138:139]
    v_pk_fma_f32 v[36:37], v[36:37], v[180:181], v[140:141]
    v_pk_fma_f32 v[38:39], v[38:39], v[182:183], v[142:143]
    v_cvt_pk_bf16_f32 v116, v32, v33
    v_cvt_pk_bf16_f32 v117, v34, v35
    v_cvt_pk_bf16_f32 v118, v36, v37
    v_cvt_pk_bf16_f32 v119, v38, v39
    ds_write_b128 v254, v[116:119] offset:3264
    s_cmp_eq_u32 s25, 0
    s_cselect_b32 s27, 0, 0
    s_add_u32 s40, s6, s27
    s_addc_u32 s41, s7, 0
    s_add_u32 s40, s40, 2162688
    s_addc_u32 s41, s41, 0
    s_mov_b32 s42, 0x400000
    s_mov_b32 s43, 0x20000
    v_lshrrev_b32 v8, 3, v1
    v_lshlrev_b32 v8, 8, v8
    v_and_b32 v9, 7, v1
    v_lshl_add_u32 v8, v9, 4, v8
    s_lshl_b32 s52, s54, 2
    s_lshr_b32 s53, s55, 1
    s_add_u32 s52, s52, s53
    s_lshl_b32 s52, s52, 14
    s_and_b32 s53, s55, 1
    s_lshl_b32 s53, s53, 7
    s_add_u32 s52, s52, s53
    s_and_b32 s53, s21, 1
    s_lshl_b32 s53, s53, 13
    s_add_u32 s52, s52, s53
    s_lshr_b32 s53, s21, 1
    s_lshl_b32 s53, s53, 21
    s_add_u32 s52, s52, s53
    s_add_u32 s53, s52, 4096
    v_mov_b32 v12, 162880
    v_mov_b32 v13, 1
    s_mov_b64 exec, 1
    ds_add_u32 v12, v13 offset:20
    s_mov_b64 exec, -1
LW6:
    ds_read_b32 v14, v12 offset:20
    s_waitcnt lgkmcnt(0)
    v_readfirstlane_b32 s27, v14
    s_cmp_eq_u32 s24, 0
    s_cbranch_scc1 LW6_X
    s_sub_u32 s24, s24, 1
    s_cmp_lt_u32 s27, 4
    s_cbranch_scc1 LW6
LW6_X:
    ds_read_b128 v[16:19], v255 offset:0
    ds_read_b128 v[20:23], v255 offset:128
    ds_read_b128 v[24:27], v255 offset:256
    ds_read_b128 v[28:31], v255 offset:384
    s_waitcnt lgkmcnt(3)
    buffer_store_dwordx4 v[16:19], v8, s[40:43], s52 offen offset:0 sc1
    s_waitcnt lgkmcnt(2)
    buffer_store_dwordx4 v[20:23], v8, s[40:43], s52 offen offset:2048 sc1
    s_waitcnt lgkmcnt(1)
    buffer_store_dwordx4 v[24:27], v8, s[40:43], s53 offen offset:0 sc1
    s_waitcnt lgkmcnt(0)
    buffer_store_dwordx4 v[28:31], v8, s[40:43], s53 offen offset:2048 sc1
P2_STD:
    s_bfe_u32 s54, s23, 0x10001
    s_lshl_b32 s55, s22, 1
    s_add_u32 s54, s54, s55
    s_and_b32 s55, s23, 1
    s_lshr_b32 s52, s23, 2
    s_lshl_b32 s52, s52, 1
    s_add_u32 s55, s55, s52
    s_lshl_b32 s56, s54, 3
    s_lshl_b32 s52, s21, 1
    s_add_u32 s56, s56, s52
    s_lshl_b32 s57, s56, 14
    s_add_u32 s58, s57, 16384
    s_waitcnt vmcnt(0)
    s_cmp_eq_u32 s25, 0
    s_cbranch_scc1 S2_SLOW
    s_mov_b32 s48, s6
    s_mov_b32 s49, s7
    s_mov_b32 s50, 65536
    s_mov_b32 s51, 0x20000
    v_mov_b32 v12, 162880
    v_mov_b32 v13, 1
    s_mov_b64 exec, 1
    ds_add_rtn_u32 v14, v12, v13 offset:24
    s_waitcnt lgkmcnt(0)
    v_readfirstlane_b32 s27, v14
    s_lshl_b32 s52, s54, 7
    s_add_u32 s52, s52, 36864
    s_cmp_lg_u32 s27, 3
    s_cbranch_scc1 S2_FA
    s_and_b32 s53, s23, 1
    s_lshr_b32 s63, s23, 2
    s_lshl_b32 s63, s63, 1
    s_add_u32 s53, s53, s63
    s_lshl_b32 s53, s53, 2
    v_mov_b32 v14, s53
    v_mov_b32 v13, s26
    buffer_store_dword v13, v14, s[48:51], s52 offen
S2_FA:
    s_mov_b64 exec, -1
    s_mov_b32 s63, s52
    v_lshlrev_b32 v7, 4, v1
    v_bfe_u32 v4, v1, 2, 2
    v_and_b32 v6, 1, v2
    v_lshl_add_u32 v6, v6, 2, v4
    v_lshlrev_b32 v6, 1, v6
    v_lshl_add_u32 v4, v2, 3, v4
    v_lshlrev_b32 v4, 8, v4
    v_bfe_u32 v8, v1, 1, 1
    v_lshl_add_u32 v4, v8, 4, v4
    v_and_b32 v8, 1, v1
    v_lshl_add_u32 v4, v8, 3, v4
    v_xor_b32 v8, 0, v6
    v_lshl_add_u32 v248, v8, 4, v4
    v_xor_b32 v8, 2, v6
    v_lshl_add_u32 v249, v8, 4, v4
    v_xor_b32 v8, 4, v6
    v_lshl_add_u32 v250, v8, 4, v4
    v_xor_b32 v8, 6, v6
    v_lshl_add_u32 v251, v8, 4, v4
    v_xor_b32 v8, 8, v6
    v_lshl_add_u32 v252, v8, 4, v4
    v_xor_b32 v8, 10, v6
    v_lshl_add_u32 v253, v8, 4, v4
    v_xor_b32 v8, 12, v6
    v_lshl_add_u32 v254, v8, 4, v4
    s_cmp_eq_u32 s25, 0
    s_cselect_b32 s27, 0, 0
    s_add_u32 s32, s6, s27
    s_addc_u32 s33, s7, 0
    s_add_u32 s32, s32, 4259840
    s_addc_u32 s33, s33, 0
    s_mov_b32 s34, 2097152
    s_mov_b32 s35, 0x20000
    s_cmp_eq_u32 s25, 0
    s_cselect_b32 s27, 0, 0
    s_add_u32 s44, s6, s27
    s_addc_u32 s45, s7, 0
    s_add_u32 s44, s44, 6356992
    s_addc_u32 s45, s45, 0
    s_mov_b32 s46, 7340032
    s_mov_b32 s47, 0x20000
    s_cmp_lg_u32 s20, 0
    s_cbranch_scc1 S2_FW
    v_lshlrev_b32 v13, 2, v1
    s_mov_b64 exec, 0xffff
S2_FP:
    buffer_load_dword v14, v13, s[48:51], s63 offen sc1
    s_waitcnt vmcnt(0)
    s_cmp_eq_u32 s24, 0
    s_cbranch_scc1 S2_FX
    s_sub_u32 s24, s24, 1
    v_cmp_ne_u32 vcc, s26, v14
    s_cbranch_vccnz S2_FP
S2_FX:
    s_mov_b64 exec, 1
    v_mov_b32 v12, 162880
    v_mov_b32 v13, 1
    ds_write_b32 v12, v13 offset:28
    s_mov_b64 exec, -1
    s_branch S2_DONE
S2_FW:
    v_mov_b32 v12, 162880
LW7:
    ds_read_b32 v14, v12 offset:28
    s_waitcnt lgkmcnt(0)
    v_readfirstlane_b32 s27, v14
    s_cmp_eq_u32 s24, 0
    s_cbranch_scc1 LW7_X
    s_sub_u32 s24, s24, 1
    s_cmp_lt_u32 s27, 1
    s_cbranch_scc1 LW7
LW7_X:
    s_branch S2_DONE
S2_SLOW:
    s_add_u32 s48, s6, 16384
    s_addc_u32 s49, s7, 0
    s_mov_b32 s50, 11264
    s_mov_b32 s51, 0x20000
    v_mov_b32 v12, 162880
    v_mov_b32 v13, 1
    s_mov_b64 exec, 1
    ds_add_rtn_u32 v14, v12, v13 offset:24
    s_waitcnt lgkmcnt(0)
    v_readfirstlane_b32 s27, v14
    s_cmp_lg_u32 s27, 3
    s_cbranch_scc1 S2_A
    s_lshl_b32 s52, s54, 7
    s_add_u32 s52, s52, 3072
    v_mov_b32 v14, s52
    buffer_atomic_add v13, v14, s[48:51], 0 offen
S2_A:
    s_mov_b64 exec, -1
    v_lshlrev_b32 v7, 4, v1
    v_bfe_u32 v4, v1, 2, 2
    v_and_b32 v6, 1, v2
    v_lshl_add_u32 v6, v6, 2, v4
    v_lshlrev_b32 v6, 1, v6
    v_lshl_add_u32 v4, v2, 3, v4
    v_lshlrev_b32 v4, 8, v4
    v_bfe_u32 v8, v1, 1, 1
    v_lshl_add_u32 v4, v8, 4, v4
    v_and_b32 v8, 1, v1
    v_lshl_add_u32 v4, v8, 3, v4
    v_xor_b32 v8, 0, v6
    v_lshl_add_u32 v248, v8, 4, v4
    v_xor_b32 v8, 2, v6
    v_lshl_add_u32 v249, v8, 4, v4
    v_xor_b32 v8, 4, v6
    v_lshl_add_u32 v250, v8, 4, v4
    v_xor_b32 v8, 6, v6
    v_lshl_add_u32 v251, v8, 4, v4
    v_xor_b32 v8, 8, v6
    v_lshl_add_u32 v252, v8, 4, v4
    v_xor_b32 v8, 10, v6
    v_lshl_add_u32 v253, v8, 4, v4
    v_xor_b32 v8, 12, v6
    v_lshl_add_u32 v254, v8, 4, v4
    s_cmp_eq_u32 s25, 0
    s_cselect_b32 s27, 0, 0
    s_add_u32 s32, s6, s27
    s_addc_u32 s33, s7, 0
    s_add_u32 s32, s32, 4259840
    s_addc_u32 s33, s33, 0
    s_mov_b32 s34, 2097152
    s_mov_b32 s35, 0x20000
    s_cmp_eq_u32 s25, 0
    s_cselect_b32 s27, 0, 0
    s_add_u32 s44, s6, s27
    s_addc_u32 s45, s7, 0
    s_add_u32 s44, s44, 6356992
    s_addc_u32 s45, s45, 0
    s_mov_b32 s46, 7340032
    s_mov_b32 s47, 0x20000
    s_cmp_lg_u32 s20, 0
    s_cbranch_scc1 S2_W
    s_and_b32 s52, s23, 29
    s_cmp_eq_u32 s52, 0
    s_cbranch_scc0 S2_O
    s_lshl_b32 s52, s54, 7
    s_add_u32 s52, s52, 3072
    v_mov_b32 v13, s52
    s_mov_b64 exec, 0x1
    s_mov_b32 s100, 0
S2_P:
    s_add_u32 s100, s100, 1
    s_and_b32 s101, s100, 1023
    s_cmp_eq_u32 s101, 0
    s_cbranch_scc1 S2_P_AT
    buffer_load_dword v14, v13, s[48:51], 0 offen sc1
    s_branch S2_P_WT
S2_P_AT:
    v_mov_b32 v14, 0
    buffer_atomic_add v14, v13, s[48:51], 0 offen sc0
S2_P_WT:
    s_waitcnt vmcnt(0)
    s_cmp_eq_u32 s24, 0
    s_cbranch_scc1 S2_R
    s_sub_u32 s24, s24, 1
    v_cmp_gt_u32 vcc, 16, v14
    s_cbranch_vccnz S2_P
S2_R:
    s_mov_b64 exec, 0x1
    s_lshl_b32 s52, s54, 7
    s_add_u32 s52, s52, 5120
    v_mov_b32 v13, s52
    v_mov_b32 v14, s26
    buffer_store_dword v14, v13, s[48:51], 0 offen sc1
    s_branch S2_X
S2_O:
    s_lshl_b32 s52, s54, 7
    s_add_u32 s52, s52, 5120
    v_mov_b32 v13, s52
    s_mov_b64 exec, 1
    s_mov_b32 s100, 0
S2_Q:
    s_add_u32 s100, s100, 1
    s_and_b32 s101, s100, 1023
    s_cmp_eq_u32 s101, 0
    s_cbranch_scc1 S2_Q_AT
    buffer_load_dword v14, v13, s[48:51], 0 offen sc1
    s_branch S2_Q_WT
S2_Q_AT:
    v_mov_b32 v14, 0
    buffer_atomic_add v14, v13, s[48:51], 0 offen sc0
S2_Q_WT:
    s_waitcnt vmcnt(0)
    v_readfirstlane_b32 s27, v14
    s_cmp_eq_u32 s24, 0
    s_cbranch_scc1 S2_X
    s_sub_u32 s24, s24, 1
    s_cmp_lg_u32 s27, s26
    s_cbranch_scc1 S2_Q
S2_X:
    s_mov_b64 exec, 1
    v_mov_b32 v12, 162880
    v_mov_b32 v13, 1
    ds_write_b32 v12, v13 offset:28
    s_mov_b64 exec, -1
    s_branch S2_D
S2_W:
    v_mov_b32 v12, 162880
LW8:
    ds_read_b32 v14, v12 offset:28
    s_waitcnt lgkmcnt(0)
    v_readfirstlane_b32 s27, v14
    s_cmp_eq_u32 s24, 0
    s_cbranch_scc1 LW8_X
    s_sub_u32 s24, s24, 1
    s_cmp_lt_u32 s27, 1
    s_cbranch_scc1 LW8
LW8_X:
S2_D:
S2_DONE:
    buffer_load_dwordx4 v[64:67], v7, s[32:35], s57 offen offset:0 sc1
    buffer_load_dwordx4 v[68:71], v7, s[32:35], s58 offen offset:0 sc1
    buffer_load_dwordx4 v[72:75], v7, s[32:35], s57 offen offset:1024 sc1
    buffer_load_dwordx4 v[76:79], v7, s[32:35], s58 offen offset:1024 sc1
    buffer_load_dwordx4 v[80:83], v7, s[32:35], s57 offen offset:2048 sc1
    buffer_load_dwordx4 v[84:87], v7, s[32:35], s58 offen offset:2048 sc1
    buffer_load_dwordx4 v[88:91], v7, s[32:35], s57 offen offset:3072 sc1
    buffer_load_dwordx4 v[92:95], v7, s[32:35], s58 offen offset:3072 sc1
    s_add_u32 s57, s57, 4096
    s_add_u32 s58, s58, 4096
    buffer_load_dwordx4 v[96:99], v7, s[32:35], s57 offen offset:0 sc1
    buffer_load_dwordx4 v[100:103], v7, s[32:35], s58 offen offset:0 sc1
    buffer_load_dwordx4 v[104:107], v7, s[32:35], s57 offen offset:1024 sc1
    buffer_load_dwordx4 v[108:111], v7, s[32:35], s58 offen offset:1024 sc1
    v_mov_b32 v12, 162880
LW9:
    ds_read_b32 v14, v12 offset:32
    s_waitcnt lgkmcnt(0)
    v_readfirstlane_b32 s27, v14
    s_cmp_eq_u32 s24, 0
    s_cbranch_scc1 LW9_X
    s_sub_u32 s24, s24, 1
    s_cmp_lt_u32 s27, 4
    s_cbranch_scc1 LW9
LW9_X:
    v_mov_b32 v4, 162880
    v_mov_b32 v5, 1
    ds_read_b64_tr_b16 v[192:193], v248 offset:0
    ds_read_b64_tr_b16 v[194:195], v248 offset:1024
    ds_read_b64_tr_b16 v[196:197], v249 offset:0
    ds_read_b64_tr_b16 v[198:199], v249 offset:1024
    ds_read_b64_tr_b16 v[200:201], v250 offset:0
    ds_read_b64_tr_b16 v[202:203], v250 offset:1024
    ds_read_b64_tr_b16 v[204:205], v251 offset:0
    ds_read_b64_tr_b16 v[206:207], v251 offset:1024
    ds_read_b64_tr_b16 v[208:209], v252 offset:0
    ds_read_b64_tr_b16 v[210:211], v252 offset:1024
    ds_read_b64_tr_b16 v[212:213], v253 offset:0
    ds_read_b64_tr_b16 v[214:215], v253 offset:1024
    ds_read_b64_tr_b16 v[216:217], v254 offset:0
    ds_read_b64_tr_b16 v[218:219], v254 offset:1024
    s_waitcnt vmcnt(10)
    s_waitcnt lgkmcnt(12)
    v_mfma_f32_16x16x32_bf16 v[8:11], v[192:195], v[64:67], 0
    ds_read_b64_tr_b16 v[220:221], v248 offset:8192
    v_mfma_f32_16x16x32_bf16 v[36:39], v[192:195], v[68:71], 0
    ds_read_b64_tr_b16 v[222:223], v248 offset:9216
    s_waitcnt lgkmcnt(12)
    v_mfma_f32_16x16x32_bf16 v[12:15], v[196:199], v[64:67], 0
    ds_read_b64_tr_b16 v[224:225], v249 offset:8192
    v_mfma_f32_16x16x32_bf16 v[40:43], v[196:199], v[68:71], 0
    ds_read_b64_tr_b16 v[226:227], v249 offset:9216
    s_waitcnt lgkmcnt(12)
    v_mfma_f32_16x16x32_bf16 v[16:19], v[200:203], v[64:67], 0
    ds_read_b64_tr_b16 v[228:229], v250 offset:8192
    v_mfma_f32_16x16x32_bf16 v[44:47], v[200:203], v[68:71], 0
    ds_read_b64_tr_b16 v[230:231], v250 offset:9216
    buffer_load_dwordx4 v[112:115], v7, s[32:35], s57 offen offset:2048 sc1
    s_waitcnt lgkmcnt(12)
    v_mfma_f32_16x16x32_bf16 v[20:23], v[204:207], v[64:67], 0
    ds_read_b64_tr_b16 v[232:233], v251 offset:8192
    v_mfma_f32_16x16x32_bf16 v[48:51], v[204:207], v[68:71], 0
    ds_read_b64_tr_b16 v[234:235], v251 offset:9216
    s_waitcnt lgkmcnt(12)
    v_mfma_f32_16x16x32_bf16 v[24:27], v[208:211], v[64:67], 0
    ds_read_b64_tr_b16 v[236:237], v252 offset:8192
    v_mfma_f32_16x16x32_bf16 v[52:55], v[208:211], v[68:71], 0
    ds_read_b64_tr_b16 v[238:239], v252 offset:9216
    s_waitcnt lgkmcnt(12)
    v_mfma_f32_16x16x32_bf16 v[28:31], v[212:215], v[64:67], 0
    ds_read_b64_tr_b16 v[240:241], v253 offset:8192
    v_mfma_f32_16x16x32_bf16 v[56:59], v[212:215], v[68:71], 0
    ds_read_b64_tr_b16 v[242:243], v253 offset:9216
    buffer_load_dwordx4 v[116:119], v7, s[32:35], s58 offen offset:2048 sc1
    s_waitcnt lgkmcnt(12)
    v_mfma_f32_16x16x32_bf16 v[32:35], v[216:219], v[64:67], 0
    ds_read_b64_tr_b16 v[244:245], v254 offset:8192
    v_mfma_f32_16x16x32_bf16 v[60:63], v[216:219], v[68:71], 0
    ds_read_b64_tr_b16 v[246:247], v254 offset:9216
    s_waitcnt vmcnt(10)
    s_waitcnt lgkmcnt(12)
    v_mfma_f32_16x16x32_bf16 v[8:11], v[220:223], v[72:75], v[8:11]
    ds_read_b64_tr_b16 v[192:193], v248 offset:16384
    v_mfma_f32_16x16x32_bf16 v[36:39], v[220:223], v[76:79], v[36:39]
    ds_read_b64_tr_b16 v[194:195], v248 offset:17408
    s_waitcnt lgkmcnt(12)
    v_mfma_f32_16x16x32_bf16 v[12:15], v[224:227], v[72:75], v[12:15]
    ds_read_b64_tr_b16 v[196:197], v249 offset:16384
    v_mfma_f32_16x16x32_bf16 v[40:43], v[224:227], v[76:79], v[40:43]
    ds_read_b64_tr_b16 v[198:199], v249 offset:17408
    s_waitcnt lgkmcnt(12)
    v_mfma_f32_16x16x32_bf16 v[16:19], v[228:231], v[72:75], v[16:19]
    ds_read_b64_tr_b16 v[200:201], v250 offset:16384
    v_mfma_f32_16x16x32_bf16 v[44:47], v[228:231], v[76:79], v[44:47]
    ds_read_b64_tr_b16 v[202:203], v250 offset:17408
    buffer_load_dwordx4 v[120:123], v7, s[32:35], s57 offen offset:3072 sc1
    s_waitcnt lgkmcnt(12)
    v_mfma_f32_16x16x32_bf16 v[20:23], v[232:235], v[72:75], v[20:23]
    ds_read_b64_tr_b16 v[204:205], v251 offset:16384
    v_mfma_f32_16x16x32_bf16 v[48:51], v[232:235], v[76:79], v[48:51]
    ds_read_b64_tr_b16 v[206:207], v251 offset:17408
    s_waitcnt lgkmcnt(12)
    v_mfma_f32_16x16x32_bf16 v[24:27], v[236:239], v[72:75], v[24:27]
    ds_read_b64_tr_b16 v[208:209], v252 offset:16384
    v_mfma_f32_16x16x32_bf16 v[52:55], v[236:239], v[76:79], v[52:55]
    ds_read_b64_tr_b16 v[210:211], v252 offset:17408
    s_waitcnt lgkmcnt(12)
    v_mfma_f32_16x16x32_bf16 v[28:31], v[240:243], v[72:75], v[28:31]
    ds_read_b64_tr_b16 v[212:213], v253 offset:16384
    v_mfma_f32_16x16x32_bf16 v[56:59], v[240:243], v[76:79], v[56:59]
    ds_read_b64_tr_b16 v[214:215], v253 offset:17408
    buffer_load_dwordx4 v[124:127], v7, s[32:35], s58 offen offset:3072 sc1
    s_add_u32 s57, s57, 4096
    s_add_u32 s58, s58, 4096
    s_waitcnt lgkmcnt(12)
    v_mfma_f32_16x16x32_bf16 v[32:35], v[244:247], v[72:75], v[32:35]
    ds_read_b64_tr_b16 v[216:217], v254 offset:16384
    v_mfma_f32_16x16x32_bf16 v[60:63], v[244:247], v[76:79], v[60:63]
    ds_read_b64_tr_b16 v[218:219], v254 offset:17408
    s_waitcnt vmcnt(10)
    s_waitcnt lgkmcnt(12)
    v_mfma_f32_16x16x32_bf16 v[8:11], v[192:195], v[80:83], v[8:11]
    ds_read_b64_tr_b16 v[220:221], v248 offset:24576
    v_mfma_f32_16x16x32_bf16 v[36:39], v[192:195], v[84:87], v[36:39]
    ds_read_b64_tr_b16 v[222:223], v248 offset:25600
    s_waitcnt lgkmcnt(12)
    v_mfma_f32_16x16x32_bf16 v[12:15], v[196:199], v[80:83], v[12:15]
    ds_read_b64_tr_b16 v[224:225], v249 offset:24576
    v_mfma_f32_16x16x32_bf16 v[40:43], v[196:199], v[84:87], v[40:43]
    ds_read_b64_tr_b16 v[226:227], v249 offset:25600
    s_waitcnt lgkmcnt(12)
    v_mfma_f32_16x16x32_bf16 v[16:19], v[200:203], v[80:83], v[16:19]
    ds_read_b64_tr_b16 v[228:229], v250 offset:24576
    v_mfma_f32_16x16x32_bf16 v[44:47], v[200:203], v[84:87], v[44:47]
    ds_read_b64_tr_b16 v[230:231], v250 offset:25600
    buffer_load_dwordx4 v[128:131], v7, s[32:35], s57 offen offset:0 sc1
    s_waitcnt lgkmcnt(12)
    v_mfma_f32_16x16x32_bf16 v[20:23], v[204:207], v[80:83], v[20:23]
    ds_read_b64_tr_b16 v[232:233], v251 offset:24576
    v_mfma_f32_16x16x32_bf16 v[48:51], v[204:207], v[84:87], v[48:51]
    ds_read_b64_tr_b16 v[234:235], v251 offset:25600
    s_waitcnt lgkmcnt(12)
    v_mfma_f32_16x16x32_bf16 v[24:27], v[208:211], v[80:83], v[24:27]
    ds_read_b64_tr_b16 v[236:237], v252 offset:24576
    v_mfma_f32_16x16x32_bf16 v[52:55], v[208:211], v[84:87], v[52:55]
    ds_read_b64_tr_b16 v[238:239], v252 offset:25600
    s_waitcnt lgkmcnt(12)
    v_mfma_f32_16x16x32_bf16 v[28:31], v[212:215], v[80:83], v[28:31]
    ds_read_b64_tr_b16 v[240:241], v253 offset:24576
    v_mfma_f32_16x16x32_bf16 v[56:59], v[212:215], v[84:87], v[56:59]
    ds_read_b64_tr_b16 v[242:243], v253 offset:25600
    buffer_load_dwordx4 v[132:135], v7, s[32:35], s58 offen offset:0 sc1
    s_waitcnt lgkmcnt(12)
    v_mfma_f32_16x16x32_bf16 v[32:35], v[216:219], v[80:83], v[32:35]
    ds_read_b64_tr_b16 v[244:245], v254 offset:24576
    v_mfma_f32_16x16x32_bf16 v[60:63], v[216:219], v[84:87], v[60:63]
    ds_read_b64_tr_b16 v[246:247], v254 offset:25600
    s_waitcnt vmcnt(10)
    s_waitcnt lgkmcnt(12)
    v_mfma_f32_16x16x32_bf16 v[8:11], v[220:223], v[88:91], v[8:11]
    ds_read_b64_tr_b16 v[192:193], v248 offset:32768
    v_mfma_f32_16x16x32_bf16 v[36:39], v[220:223], v[92:95], v[36:39]
    ds_read_b64_tr_b16 v[194:195], v248 offset:33792
    s_waitcnt lgkmcnt(12)
    v_mfma_f32_16x16x32_bf16 v[12:15], v[224:227], v[88:91], v[12:15]
    ds_read_b64_tr_b16 v[196:197], v249 offset:32768
    v_mfma_f32_16x16x32_bf16 v[40:43], v[224:227], v[92:95], v[40:43]
    ds_read_b64_tr_b16 v[198:199], v249 offset:33792
    s_waitcnt lgkmcnt(12)
    v_mfma_f32_16x16x32_bf16 v[16:19], v[228:231], v[88:91], v[16:19]
    ds_read_b64_tr_b16 v[200:201], v250 offset:32768
    v_mfma_f32_16x16x32_bf16 v[44:47], v[228:231], v[92:95], v[44:47]
    ds_read_b64_tr_b16 v[202:203], v250 offset:33792
    buffer_load_dwordx4 v[136:139], v7, s[32:35], s57 offen offset:1024 sc1
    s_waitcnt lgkmcnt(12)
    v_mfma_f32_16x16x32_bf16 v[20:23], v[232:235], v[88:91], v[20:23]
    ds_read_b64_tr_b16 v[204:205], v251 offset:32768
    v_mfma_f32_16x16x32_bf16 v[48:51], v[232:235], v[92:95], v[48:51]
    ds_read_b64_tr_b16 v[206:207], v251 offset:33792
    s_waitcnt lgkmcnt(12)
    v_mfma_f32_16x16x32_bf16 v[24:27], v[236:239], v[88:91], v[24:27]
    ds_read_b64_tr_b16 v[208:209], v252 offset:32768
    v_mfma_f32_16x16x32_bf16 v[52:55], v[236:239], v[92:95], v[52:55]
    ds_read_b64_tr_b16 v[210:211], v252 offset:33792
    s_waitcnt lgkmcnt(12)
    v_mfma_f32_16x16x32_bf16 v[28:31], v[240:243], v[88:91], v[28:31]
    ds_read_b64_tr_b16 v[212:213], v253 offset:32768
    v_mfma_f32_16x16x32_bf16 v[56:59], v[240:243], v[92:95], v[56:59]
    ds_read_b64_tr_b16 v[214:215], v253 offset:33792
    buffer_load_dwordx4 v[140:143], v7, s[32:35], s58 offen offset:1024 sc1
    s_waitcnt lgkmcnt(12)
    v_mfma_f32_16x16x32_bf16 v[32:35], v[244:247], v[88:91], v[32:35]
    ds_read_b64_tr_b16 v[216:217], v254 offset:32768
    v_mfma_f32_16x16x32_bf16 v[60:63], v[244:247], v[92:95], v[60:63]
    ds_read_b64_tr_b16 v[218:219], v254 offset:33792
    s_waitcnt vmcnt(10)
    s_waitcnt lgkmcnt(12)
    v_mfma_f32_16x16x32_bf16 v[8:11], v[192:195], v[96:99], v[8:11]
    ds_read_b64_tr_b16 v[220:221], v248 offset:40960
    v_mfma_f32_16x16x32_bf16 v[36:39], v[192:195], v[100:103], v[36:39]
    ds_read_b64_tr_b16 v[222:223], v248 offset:41984
    s_waitcnt lgkmcnt(12)
    v_mfma_f32_16x16x32_bf16 v[12:15], v[196:199], v[96:99], v[12:15]
    ds_read_b64_tr_b16 v[224:225], v249 offset:40960
    v_mfma_f32_16x16x32_bf16 v[40:43], v[196:199], v[100:103], v[40:43]
    ds_read_b64_tr_b16 v[226:227], v249 offset:41984
    s_waitcnt lgkmcnt(12)
    v_mfma_f32_16x16x32_bf16 v[16:19], v[200:203], v[96:99], v[16:19]
    ds_read_b64_tr_b16 v[228:229], v250 offset:40960
    v_mfma_f32_16x16x32_bf16 v[44:47], v[200:203], v[100:103], v[44:47]
    ds_read_b64_tr_b16 v[230:231], v250 offset:41984
    buffer_load_dwordx4 v[144:147], v7, s[32:35], s57 offen offset:2048 sc1
    s_waitcnt lgkmcnt(12)
    v_mfma_f32_16x16x32_bf16 v[20:23], v[204:207], v[96:99], v[20:23]
    ds_read_b64_tr_b16 v[232:233], v251 offset:40960
    v_mfma_f32_16x16x32_bf16 v[48:51], v[204:207], v[100:103], v[48:51]
    ds_read_b64_tr_b16 v[234:235], v251 offset:41984
    s_waitcnt lgkmcnt(12)
    v_mfma_f32_16x16x32_bf16 v[24:27], v[208:211], v[96:99], v[24:27]
    ds_read_b64_tr_b16 v[236:237], v252 offset:40960
    v_mfma_f32_16x16x32_bf16 v[52:55], v[208:211], v[100:103], v[52:55]
    ds_read_b64_tr_b16 v[238:239], v252 offset:41984
    s_waitcnt lgkmcnt(12)
    v_mfma_f32_16x16x32_bf16 v[28:31], v[212:215], v[96:99], v[28:31]
    ds_read_b64_tr_b16 v[240:241], v253 offset:40960
    v_mfma_f32_16x16x32_bf16 v[56:59], v[212:215], v[100:103], v[56:59]
    ds_read_b64_tr_b16 v[242:243], v253 offset:41984
    buffer_load_dwordx4 v[148:151], v7, s[32:35], s58 offen offset:2048 sc1
    s_waitcnt lgkmcnt(12)
    v_mfma_f32_16x16x32_bf16 v[32:35], v[216:219], v[96:99], v[32:35]
    ds_read_b64_tr_b16 v[244:245], v254 offset:40960
    v_mfma_f32_16x16x32_bf16 v[60:63], v[216:219], v[100:103], v[60:63]
    ds_read_b64_tr_b16 v[246:247], v254 offset:41984
    s_mov_b64 exec, 1
    ds_add_u32 v4, v5 offset:64
    s_mov_b64 exec, -1
    s_waitcnt vmcnt(10)
    s_waitcnt lgkmcnt(12)
    v_mfma_f32_16x16x32_bf16 v[8:11], v[220:223], v[104:107], v[8:11]
    ds_read_b64_tr_b16 v[192:193], v248 offset:49152
    v_mfma_f32_16x16x32_bf16 v[36:39], v[220:223], v[108:111], v[36:39]
    ds_read_b64_tr_b16 v[194:195], v248 offset:50176
    s_waitcnt lgkmcnt(12)
    v_mfma_f32_16x16x32_bf16 v[12:15], v[224:227], v[104:107], v[12:15]
    ds_read_b64_tr_b16 v[196:197], v249 offset:49152
    v_mfma_f32_16x16x32_bf16 v[40:43], v[224:227], v[108:111], v[40:43]
    ds_read_b64_tr_b16 v[198:199], v249 offset:50176
    s_waitcnt lgkmcnt(12)
    v_mfma_f32_16x16x32_bf16 v[16:19], v[228:231], v[104:107], v[16:19]
    ds_read_b64_tr_b16 v[200:201], v250 offset:49152
    v_mfma_f32_16x16x32_bf16 v[44:47], v[228:231], v[108:111], v[44:47]
    ds_read_b64_tr_b16 v[202:203], v250 offset:50176
    buffer_load_dwordx4 v[152:155], v7, s[32:35], s57 offen offset:3072 sc1
    s_waitcnt lgkmcnt(12)
    v_mfma_f32_16x16x32_bf16 v[20:23], v[232:235], v[104:107], v[20:23]
    ds_read_b64_tr_b16 v[204:205], v251 offset:49152
    v_mfma_f32_16x16x32_bf16 v[48:51], v[232:235], v[108:111], v[48:51]
    ds_read_b64_tr_b16 v[206:207], v251 offset:50176
    s_waitcnt lgkmcnt(12)
    v_mfma_f32_16x16x32_bf16 v[24:27], v[236:239], v[104:107], v[24:27]
    ds_read_b64_tr_b16 v[208:209], v252 offset:49152
    v_mfma_f32_16x16x32_bf16 v[52:55], v[236:239], v[108:111], v[52:55]
    ds_read_b64_tr_b16 v[210:211], v252 offset:50176
    s_waitcnt lgkmcnt(12)
    v_mfma_f32_16x16x32_bf16 v[28:31], v[240:243], v[104:107], v[28:31]
    ds_read_b64_tr_b16 v[212:213], v253 offset:49152
    v_mfma_f32_16x16x32_bf16 v[56:59], v[240:243], v[108:111], v[56:59]
    ds_read_b64_tr_b16 v[214:215], v253 offset:50176
    buffer_load_dwordx4 v[156:159], v7, s[32:35], s58 offen offset:3072 sc1
    s_add_u32 s57, s57, 4096
    s_add_u32 s58, s58, 4096
    s_waitcnt lgkmcnt(12)
    v_mfma_f32_16x16x32_bf16 v[32:35], v[244:247], v[104:107], v[32:35]
    ds_read_b64_tr_b16 v[216:217], v254 offset:49152
    v_mfma_f32_16x16x32_bf16 v[60:63], v[244:247], v[108:111], v[60:63]
    ds_read_b64_tr_b16 v[218:219], v254 offset:50176
    s_waitcnt vmcnt(10)
    s_waitcnt lgkmcnt(12)
    v_mfma_f32_16x16x32_bf16 v[8:11], v[192:195], v[112:115], v[8:11]
    ds_read_b64_tr_b16 v[220:221], v248 offset:57344
    v_mfma_f32_16x16x32_bf16 v[36:39], v[192:195], v[116:119], v[36:39]
    ds_read_b64_tr_b16 v[222:223], v248 offset:58368
    s_waitcnt lgkmcnt(12)
    v_mfma_f32_16x16x32_bf16 v[12:15], v[196:199], v[112:115], v[12:15]
    ds_read_b64_tr_b16 v[224:225], v249 offset:57344
    v_mfma_f32_16x16x32_bf16 v[40:43], v[196:199], v[116:119], v[40:43]
    ds_read_b64_tr_b16 v[226:227], v249 offset:58368
    s_waitcnt lgkmcnt(12)
    v_mfma_f32_16x16x32_bf16 v[16:19], v[200:203], v[112:115], v[16:19]
    ds_read_b64_tr_b16 v[228:229], v250 offset:57344
    v_mfma_f32_16x16x32_bf16 v[44:47], v[200:203], v[116:119], v[44:47]
    ds_read_b64_tr_b16 v[230:231], v250 offset:58368
    buffer_load_dwordx4 v[160:163], v7, s[32:35], s57 offen offset:0 sc1
    s_waitcnt lgkmcnt(12)
    v_mfma_f32_16x16x32_bf16 v[20:23], v[204:207], v[112:115], v[20:23]
    ds_read_b64_tr_b16 v[232:233], v251 offset:57344
    v_mfma_f32_16x16x32_bf16 v[48:51], v[204:207], v[116:119], v[48:51]
    ds_read_b64_tr_b16 v[234:235], v251 offset:58368
    s_waitcnt lgkmcnt(12)
    v_mfma_f32_16x16x32_bf16 v[24:27], v[208:211], v[112:115], v[24:27]
    ds_read_b64_tr_b16 v[236:237], v252 offset:57344
    v_mfma_f32_16x16x32_bf16 v[52:55], v[208:211], v[116:119], v[52:55]
    ds_read_b64_tr_b16 v[238:239], v252 offset:58368
    s_waitcnt lgkmcnt(12)
    v_mfma_f32_16x16x32_bf16 v[28:31], v[212:215], v[112:115], v[28:31]
    ds_read_b64_tr_b16 v[240:241], v253 offset:57344
    v_mfma_f32_16x16x32_bf16 v[56:59], v[212:215], v[116:119], v[56:59]
    ds_read_b64_tr_b16 v[242:243], v253 offset:58368
    buffer_load_dwordx4 v[164:167], v7, s[32:35], s58 offen offset:0 sc1
    s_waitcnt lgkmcnt(12)
    v_mfma_f32_16x16x32_bf16 v[32:35], v[216:219], v[112:115], v[32:35]
    ds_read_b64_tr_b16 v[244:245], v254 offset:57344
    v_mfma_f32_16x16x32_bf16 v[60:63], v[216:219], v[116:119], v[60:63]
    ds_read_b64_tr_b16 v[246:247], v254 offset:58368
    s_waitcnt vmcnt(10)
    s_waitcnt lgkmcnt(12)
    v_mfma_f32_16x16x32_bf16 v[8:11], v[220:223], v[120:123], v[8:11]
    v_add_u32 v248, 0x10000, v248
    ds_read_b64_tr_b16 v[192:193], v248 offset:0
    v_mfma_f32_16x16x32_bf16 v[36:39], v[220:223], v[124:127], v[36:39]
    ds_read_b64_tr_b16 v[194:195], v248 offset:1024
    s_waitcnt lgkmcnt(12)
    v_mfma_f32_16x16x32_bf16 v[12:15], v[224:227], v[120:123], v[12:15]
    v_add_u32 v249, 0x10000, v249
    ds_read_b64_tr_b16 v[196:197], v249 offset:0
    v_mfma_f32_16x16x32_bf16 v[40:43], v[224:227], v[124:127], v[40:43]
    ds_read_b64_tr_b16 v[198:199], v249 offset:1024
    s_waitcnt lgkmcnt(12)
    v_mfma_f32_16x16x32_bf16 v[16:19], v[228:231], v[120:123], v[16:19]
    v_add_u32 v250, 0x10000, v250
    ds_read_b64_tr_b16 v[200:201], v250 offset:0
    v_mfma_f32_16x16x32_bf16 v[44:47], v[228:231], v[124:127], v[44:47]
    ds_read_b64_tr_b16 v[202:203], v250 offset:1024
    buffer_load_dwordx4 v[168:171], v7, s[32:35], s57 offen offset:1024 sc1
    s_waitcnt lgkmcnt(12)
    v_mfma_f32_16x16x32_bf16 v[20:23], v[232:235], v[120:123], v[20:23]
    v_add_u32 v251, 0x10000, v251
    ds_read_b64_tr_b16 v[204:205], v251 offset:0
    v_mfma_f32_16x16x32_bf16 v[48:51], v[232:235], v[124:127], v[48:51]
    ds_read_b64_tr_b16 v[206:207], v251 offset:1024
    s_waitcnt lgkmcnt(12)
    v_mfma_f32_16x16x32_bf16 v[24:27], v[236:239], v[120:123], v[24:27]
    v_add_u32 v252, 0x10000, v252
    ds_read_b64_tr_b16 v[208:209], v252 offset:0
    v_mfma_f32_16x16x32_bf16 v[52:55], v[236:239], v[124:127], v[52:55]
    ds_read_b64_tr_b16 v[210:211], v252 offset:1024
    s_waitcnt lgkmcnt(12)
    v_mfma_f32_16x16x32_bf16 v[28:31], v[240:243], v[120:123], v[28:31]
    v_add_u32 v253, 0x10000, v253
    ds_read_b64_tr_b16 v[212:213], v253 offset:0
    v_mfma_f32_16x16x32_bf16 v[56:59], v[240:243], v[124:127], v[56:59]
    ds_read_b64_tr_b16 v[214:215], v253 offset:1024
    buffer_load_dwordx4 v[172:175], v7, s[32:35], s58 offen offset:1024 sc1
    s_waitcnt lgkmcnt(12)
    v_mfma_f32_16x16x32_bf16 v[32:35], v[244:247], v[120:123], v[32:35]
    v_add_u32 v254, 0x10000, v254
    ds_read_b64_tr_b16 v[216:217], v254 offset:0
    v_mfma_f32_16x16x32_bf16 v[60:63], v[244:247], v[124:127], v[60:63]
    ds_read_b64_tr_b16 v[218:219], v254 offset:1024
    s_waitcnt vmcnt(10)
    s_waitcnt lgkmcnt(12)
    v_mfma_f32_16x16x32_bf16 v[8:11], v[192:195], v[128:131], v[8:11]
    ds_read_b64_tr_b16 v[220:221], v248 offset:8192
    v_mfma_f32_16x16x32_bf16 v[36:39], v[192:195], v[132:135], v[36:39]
    ds_read_b64_tr_b16 v[222:223], v248 offset:9216
    s_waitcnt lgkmcnt(12)
    v_mfma_f32_16x16x32_bf16 v[12:15], v[196:199], v[128:131], v[12:15]
    ds_read_b64_tr_b16 v[224:225], v249 offset:8192
    v_mfma_f32_16x16x32_bf16 v[40:43], v[196:199], v[132:135], v[40:43]
    ds_read_b64_tr_b16 v[226:227], v249 offset:9216
    s_waitcnt lgkmcnt(12)
    v_mfma_f32_16x16x32_bf16 v[16:19], v[200:203], v[128:131], v[16:19]
    ds_read_b64_tr_b16 v[228:229], v250 offset:8192
    v_mfma_f32_16x16x32_bf16 v[44:47], v[200:203], v[132:135], v[44:47]
    ds_read_b64_tr_b16 v[230:231], v250 offset:9216
    buffer_load_dwordx4 v[176:179], v7, s[32:35], s57 offen offset:2048 sc1
    s_waitcnt lgkmcnt(12)
    v_mfma_f32_16x16x32_bf16 v[20:23], v[204:207], v[128:131], v[20:23]
    ds_read_b64_tr_b16 v[232:233], v251 offset:8192
    v_mfma_f32_16x16x32_bf16 v[48:51], v[204:207], v[132:135], v[48:51]
    ds_read_b64_tr_b16 v[234:235], v251 offset:9216
    s_waitcnt lgkmcnt(12)
    v_mfma_f32_16x16x32_bf16 v[24:27], v[208:211], v[128:131], v[24:27]
    ds_read_b64_tr_b16 v[236:237], v252 offset:8192
    v_mfma_f32_16x16x32_bf16 v[52:55], v[208:211], v[132:135], v[52:55]
    ds_read_b64_tr_b16 v[238:239], v252 offset:9216
    s_waitcnt lgkmcnt(12)
    v_mfma_f32_16x16x32_bf16 v[28:31], v[212:215], v[128:131], v[28:31]
    ds_read_b64_tr_b16 v[240:241], v253 offset:8192
    v_mfma_f32_16x16x32_bf16 v[56:59], v[212:215], v[132:135], v[56:59]
    ds_read_b64_tr_b16 v[242:243], v253 offset:9216
    buffer_load_dwordx4 v[180:183], v7, s[32:35], s58 offen offset:2048 sc1
    s_waitcnt lgkmcnt(12)
    v_mfma_f32_16x16x32_bf16 v[32:35], v[216:219], v[128:131], v[32:35]
    ds_read_b64_tr_b16 v[244:245], v254 offset:8192
    v_mfma_f32_16x16x32_bf16 v[60:63], v[216:219], v[132:135], v[60:63]
    ds_read_b64_tr_b16 v[246:247], v254 offset:9216
    s_mov_b64 exec, 1
    ds_add_u32 v4, v5 offset:68
    s_mov_b64 exec, -1
    s_waitcnt vmcnt(10)
    s_waitcnt lgkmcnt(12)
    v_mfma_f32_16x16x32_bf16 v[8:11], v[220:223], v[136:139], v[8:11]
    ds_read_b64_tr_b16 v[192:193], v248 offset:16384
    v_mfma_f32_16x16x32_bf16 v[36:39], v[220:223], v[140:143], v[36:39]
    ds_read_b64_tr_b16 v[194:195], v248 offset:17408
    s_waitcnt lgkmcnt(12)
    v_mfma_f32_16x16x32_bf16 v[12:15], v[224:227], v[136:139], v[12:15]
    ds_read_b64_tr_b16 v[196:197], v249 offset:16384
    v_mfma_f32_16x16x32_bf16 v[40:43], v[224:227], v[140:143], v[40:43]
    ds_read_b64_tr_b16 v[198:199], v249 offset:17408
    s_waitcnt lgkmcnt(12)
    v_mfma_f32_16x16x32_bf16 v[16:19], v[228:231], v[136:139], v[16:19]
    ds_read_b64_tr_b16 v[200:201], v250 offset:16384
    v_mfma_f32_16x16x32_bf16 v[44:47], v[228:231], v[140:143], v[44:47]
    ds_read_b64_tr_b16 v[202:203], v250 offset:17408
    buffer_load_dwordx4 v[184:187], v7, s[32:35], s57 offen offset:3072 sc1
    s_waitcnt lgkmcnt(12)
    v_mfma_f32_16x16x32_bf16 v[20:23], v[232:235], v[136:139], v[20:23]
    ds_read_b64_tr_b16 v[204:205], v251 offset:16384
    v_mfma_f32_16x16x32_bf16 v[48:51], v[232:235], v[140:143], v[48:51]
    ds_read_b64_tr_b16 v[206:207], v251 offset:17408
    s_waitcnt lgkmcnt(12)
    v_mfma_f32_16x16x32_bf16 v[24:27], v[236:239], v[136:139], v[24:27]
    ds_read_b64_tr_b16 v[208:209], v252 offset:16384
    v_mfma_f32_16x16x32_bf16 v[52:55], v[236:239], v[140:143], v[52:55]
    ds_read_b64_tr_b16 v[210:211], v252 offset:17408
    s_waitcnt lgkmcnt(12)
    v_mfma_f32_16x16x32_bf16 v[28:31], v[240:243], v[136:139], v[28:31]
    ds_read_b64_tr_b16 v[212:213], v253 offset:16384
    v_mfma_f32_16x16x32_bf16 v[56:59], v[240:243], v[140:143], v[56:59]
    ds_read_b64_tr_b16 v[214:215], v253 offset:17408
    buffer_load_dwordx4 v[188:191], v7, s[32:35], s58 offen offset:3072 sc1
    s_add_u32 s57, s57, 4096
    s_add_u32 s58, s58, 4096
    s_waitcnt lgkmcnt(12)
    v_mfma_f32_16x16x32_bf16 v[32:35], v[244:247], v[136:139], v[32:35]
    ds_read_b64_tr_b16 v[216:217], v254 offset:16384
    v_mfma_f32_16x16x32_bf16 v[60:63], v[244:247], v[140:143], v[60:63]
    ds_read_b64_tr_b16 v[218:219], v254 offset:17408
    s_waitcnt vmcnt(10)
    s_waitcnt lgkmcnt(12)
    v_mfma_f32_16x16x32_bf16 v[8:11], v[192:195], v[144:147], v[8:11]
    ds_read_b64_tr_b16 v[220:221], v248 offset:24576
    v_mfma_f32_16x16x32_bf16 v[36:39], v[192:195], v[148:151], v[36:39]
    ds_read_b64_tr_b16 v[222:223], v248 offset:25600
    s_waitcnt lgkmcnt(12)
    v_mfma_f32_16x16x32_bf16 v[12:15], v[196:199], v[144:147], v[12:15]
    ds_read_b64_tr_b16 v[224:225], v249 offset:24576
    v_mfma_f32_16x16x32_bf16 v[40:43], v[196:199], v[148:151], v[40:43]
    ds_read_b64_tr_b16 v[226:227], v249 offset:25600
    s_waitcnt lgkmcnt(12)
    v_mfma_f32_16x16x32_bf16 v[16:19], v[200:203], v[144:147], v[16:19]
    ds_read_b64_tr_b16 v[228:229], v250 offset:24576
    v_mfma_f32_16x16x32_bf16 v[44:47], v[200:203], v[148:151], v[44:47]
    ds_read_b64_tr_b16 v[230:231], v250 offset:25600
    s_waitcnt lgkmcnt(12)
    v_mfma_f32_16x16x32_bf16 v[20:23], v[204:207], v[144:147], v[20:23]
    ds_read_b64_tr_b16 v[232:233], v251 offset:24576
    v_mfma_f32_16x16x32_bf16 v[48:51], v[204:207], v[148:151], v[48:51]
    ds_read_b64_tr_b16 v[234:235], v251 offset:25600
    s_waitcnt lgkmcnt(12)
    v_mfma_f32_16x16x32_bf16 v[24:27], v[208:211], v[144:147], v[24:27]
    ds_read_b64_tr_b16 v[236:237], v252 offset:24576
    v_mfma_f32_16x16x32_bf16 v[52:55], v[208:211], v[148:151], v[52:55]
    ds_read_b64_tr_b16 v[238:239], v252 offset:25600
    s_waitcnt lgkmcnt(12)
    v_mfma_f32_16x16x32_bf16 v[28:31], v[212:215], v[144:147], v[28:31]
    ds_read_b64_tr_b16 v[240:241], v253 offset:24576
    v_mfma_f32_16x16x32_bf16 v[56:59], v[212:215], v[148:151], v[56:59]
    ds_read_b64_tr_b16 v[242:243], v253 offset:25600
    s_waitcnt lgkmcnt(12)
    v_mfma_f32_16x16x32_bf16 v[32:35], v[216:219], v[144:147], v[32:35]
    ds_read_b64_tr_b16 v[244:245], v254 offset:24576
    v_mfma_f32_16x16x32_bf16 v[60:63], v[216:219], v[148:151], v[60:63]
    ds_read_b64_tr_b16 v[246:247], v254 offset:25600
    s_waitcnt vmcnt(8)
    s_waitcnt lgkmcnt(12)
    v_mfma_f32_16x16x32_bf16 v[8:11], v[220:223], v[152:155], v[8:11]
    ds_read_b64_tr_b16 v[192:193], v248 offset:32768
    v_mfma_f32_16x16x32_bf16 v[36:39], v[220:223], v[156:159], v[36:39]
    ds_read_b64_tr_b16 v[194:195], v248 offset:33792
    s_waitcnt lgkmcnt(12)
    v_mfma_f32_16x16x32_bf16 v[12:15], v[224:227], v[152:155], v[12:15]
    ds_read_b64_tr_b16 v[196:197], v249 offset:32768
    v_mfma_f32_16x16x32_bf16 v[40:43], v[224:227], v[156:159], v[40:43]
    ds_read_b64_tr_b16 v[198:199], v249 offset:33792
    s_waitcnt lgkmcnt(12)
    v_mfma_f32_16x16x32_bf16 v[16:19], v[228:231], v[152:155], v[16:19]
    ds_read_b64_tr_b16 v[200:201], v250 offset:32768
    v_mfma_f32_16x16x32_bf16 v[44:47], v[228:231], v[156:159], v[44:47]
    ds_read_b64_tr_b16 v[202:203], v250 offset:33792
    s_waitcnt lgkmcnt(12)
    v_mfma_f32_16x16x32_bf16 v[20:23], v[232:235], v[152:155], v[20:23]
    ds_read_b64_tr_b16 v[204:205], v251 offset:32768
    v_mfma_f32_16x16x32_bf16 v[48:51], v[232:235], v[156:159], v[48:51]
    ds_read_b64_tr_b16 v[206:207], v251 offset:33792
    s_waitcnt lgkmcnt(12)
    v_mfma_f32_16x16x32_bf16 v[24:27], v[236:239], v[152:155], v[24:27]
    ds_read_b64_tr_b16 v[208:209], v252 offset:32768
    v_mfma_f32_16x16x32_bf16 v[52:55], v[236:239], v[156:159], v[52:55]
    ds_read_b64_tr_b16 v[210:211], v252 offset:33792
    s_waitcnt lgkmcnt(12)
    v_mfma_f32_16x16x32_bf16 v[28:31], v[240:243], v[152:155], v[28:31]
    ds_read_b64_tr_b16 v[212:213], v253 offset:32768
    v_mfma_f32_16x16x32_bf16 v[56:59], v[240:243], v[156:159], v[56:59]
    ds_read_b64_tr_b16 v[214:215], v253 offset:33792
    s_waitcnt lgkmcnt(12)
    v_mfma_f32_16x16x32_bf16 v[32:35], v[244:247], v[152:155], v[32:35]
    ds_read_b64_tr_b16 v[216:217], v254 offset:32768
    v_mfma_f32_16x16x32_bf16 v[60:63], v[244:247], v[156:159], v[60:63]
    ds_read_b64_tr_b16 v[218:219], v254 offset:33792
    s_waitcnt vmcnt(6)
    s_waitcnt lgkmcnt(12)
    v_mfma_f32_16x16x32_bf16 v[8:11], v[192:195], v[160:163], v[8:11]
    ds_read_b64_tr_b16 v[220:221], v248 offset:40960
    v_mfma_f32_16x16x32_bf16 v[36:39], v[192:195], v[164:167], v[36:39]
    ds_read_b64_tr_b16 v[222:223], v248 offset:41984
    s_waitcnt lgkmcnt(12)
    v_mfma_f32_16x16x32_bf16 v[12:15], v[196:199], v[160:163], v[12:15]
    ds_read_b64_tr_b16 v[224:225], v249 offset:40960
    v_mfma_f32_16x16x32_bf16 v[40:43], v[196:199], v[164:167], v[40:43]
    ds_read_b64_tr_b16 v[226:227], v249 offset:41984
    s_waitcnt lgkmcnt(12)
    v_mfma_f32_16x16x32_bf16 v[16:19], v[200:203], v[160:163], v[16:19]
    ds_read_b64_tr_b16 v[228:229], v250 offset:40960
    v_mfma_f32_16x16x32_bf16 v[44:47], v[200:203], v[164:167], v[44:47]
    ds_read_b64_tr_b16 v[230:231], v250 offset:41984
    s_waitcnt lgkmcnt(12)
    v_mfma_f32_16x16x32_bf16 v[20:23], v[204:207], v[160:163], v[20:23]
    ds_read_b64_tr_b16 v[232:233], v251 offset:40960
    v_mfma_f32_16x16x32_bf16 v[48:51], v[204:207], v[164:167], v[48:51]
    ds_read_b64_tr_b16 v[234:235], v251 offset:41984
    s_waitcnt lgkmcnt(12)
    v_mfma_f32_16x16x32_bf16 v[24:27], v[208:211], v[160:163], v[24:27]
    ds_read_b64_tr_b16 v[236:237], v252 offset:40960
    v_mfma_f32_16x16x32_bf16 v[52:55], v[208:211], v[164:167], v[52:55]
    ds_read_b64_tr_b16 v[238:239], v252 offset:41984
    s_waitcnt lgkmcnt(12)
    v_mfma_f32_16x16x32_bf16 v[28:31], v[212:215], v[160:163], v[28:31]
    ds_read_b64_tr_b16 v[240:241], v253 offset:40960
    v_mfma_f32_16x16x32_bf16 v[56:59], v[212:215], v[164:167], v[56:59]
    ds_read_b64_tr_b16 v[242:243], v253 offset:41984
    s_waitcnt lgkmcnt(12)
    v_mfma_f32_16x16x32_bf16 v[32:35], v[216:219], v[160:163], v[32:35]
    ds_read_b64_tr_b16 v[244:245], v254 offset:40960
    v_mfma_f32_16x16x32_bf16 v[60:63], v[216:219], v[164:167], v[60:63]
    ds_read_b64_tr_b16 v[246:247], v254 offset:41984
    s_waitcnt vmcnt(4)
    s_waitcnt lgkmcnt(12)
    v_mfma_f32_16x16x32_bf16 v[8:11], v[220:223], v[168:171], v[8:11]
    ds_read_b64_tr_b16 v[192:193], v248 offset:49152
    v_mfma_f32_16x16x32_bf16 v[36:39], v[220:223], v[172:175], v[36:39]
    ds_read_b64_tr_b16 v[194:195], v248 offset:50176
    s_waitcnt lgkmcnt(12)
    v_mfma_f32_16x16x32_bf16 v[12:15], v[224:227], v[168:171], v[12:15]
    ds_read_b64_tr_b16 v[196:197], v249 offset:49152
    v_mfma_f32_16x16x32_bf16 v[40:43], v[224:227], v[172:175], v[40:43]
    ds_read_b64_tr_b16 v[198:199], v249 offset:50176
    s_waitcnt lgkmcnt(12)
    v_mfma_f32_16x16x32_bf16 v[16:19], v[228:231], v[168:171], v[16:19]
    ds_read_b64_tr_b16 v[200:201], v250 offset:49152
    v_mfma_f32_16x16x32_bf16 v[44:47], v[228:231], v[172:175], v[44:47]
    ds_read_b64_tr_b16 v[202:203], v250 offset:50176
    s_waitcnt lgkmcnt(12)
    v_mfma_f32_16x16x32_bf16 v[20:23], v[232:235], v[168:171], v[20:23]
    ds_read_b64_tr_b16 v[204:205], v251 offset:49152
    v_mfma_f32_16x16x32_bf16 v[48:51], v[232:235], v[172:175], v[48:51]
    ds_read_b64_tr_b16 v[206:207], v251 offset:50176
    s_waitcnt lgkmcnt(12)
    v_mfma_f32_16x16x32_bf16 v[24:27], v[236:239], v[168:171], v[24:27]
    ds_read_b64_tr_b16 v[208:209], v252 offset:49152
    v_mfma_f32_16x16x32_bf16 v[52:55], v[236:239], v[172:175], v[52:55]
    ds_read_b64_tr_b16 v[210:211], v252 offset:50176
    s_waitcnt lgkmcnt(12)
    v_mfma_f32_16x16x32_bf16 v[28:31], v[240:243], v[168:171], v[28:31]
    ds_read_b64_tr_b16 v[212:213], v253 offset:49152
    v_mfma_f32_16x16x32_bf16 v[56:59], v[240:243], v[172:175], v[56:59]
    ds_read_b64_tr_b16 v[214:215], v253 offset:50176
    s_waitcnt lgkmcnt(12)
    v_mfma_f32_16x16x32_bf16 v[32:35], v[244:247], v[168:171], v[32:35]
    ds_read_b64_tr_b16 v[216:217], v254 offset:49152
    v_mfma_f32_16x16x32_bf16 v[60:63], v[244:247], v[172:175], v[60:63]
    ds_read_b64_tr_b16 v[218:219], v254 offset:50176
    s_mov_b64 exec, 1
    ds_add_u32 v4, v5 offset:72
    s_mov_b64 exec, -1
    s_waitcnt vmcnt(2)
    s_waitcnt lgkmcnt(12)
    v_mfma_f32_16x16x32_bf16 v[8:11], v[192:195], v[176:179], v[8:11]
    ds_read_b64_tr_b16 v[220:221], v248 offset:57344
    v_mfma_f32_16x16x32_bf16 v[36:39], v[192:195], v[180:183], v[36:39]
    ds_read_b64_tr_b16 v[222:223], v248 offset:58368
    s_waitcnt lgkmcnt(12)
    v_mfma_f32_16x16x32_bf16 v[12:15], v[196:199], v[176:179], v[12:15]
    ds_read_b64_tr_b16 v[224:225], v249 offset:57344
    v_mfma_f32_16x16x32_bf16 v[40:43], v[196:199], v[180:183], v[40:43]
    ds_read_b64_tr_b16 v[226:227], v249 offset:58368
    s_waitcnt lgkmcnt(12)
    v_mfma_f32_16x16x32_bf16 v[16:19], v[200:203], v[176:179], v[16:19]
    ds_read_b64_tr_b16 v[228:229], v250 offset:57344
    v_mfma_f32_16x16x32_bf16 v[44:47], v[200:203], v[180:183], v[44:47]
    ds_read_b64_tr_b16 v[230:231], v250 offset:58368
    s_waitcnt lgkmcnt(12)
    v_mfma_f32_16x16x32_bf16 v[20:23], v[204:207], v[176:179], v[20:23]
    ds_read_b64_tr_b16 v[232:233], v251 offset:57344
    v_mfma_f32_16x16x32_bf16 v[48:51], v[204:207], v[180:183], v[48:51]
    ds_read_b64_tr_b16 v[234:235], v251 offset:58368
    s_waitcnt lgkmcnt(12)
    v_mfma_f32_16x16x32_bf16 v[24:27], v[208:211], v[176:179], v[24:27]
    ds_read_b64_tr_b16 v[236:237], v252 offset:57344
    v_mfma_f32_16x16x32_bf16 v[52:55], v[208:211], v[180:183], v[52:55]
    ds_read_b64_tr_b16 v[238:239], v252 offset:58368
    s_waitcnt lgkmcnt(12)
    v_mfma_f32_16x16x32_bf16 v[28:31], v[212:215], v[176:179], v[28:31]
    ds_read_b64_tr_b16 v[240:241], v253 offset:57344
    v_mfma_f32_16x16x32_bf16 v[56:59], v[212:215], v[180:183], v[56:59]
    ds_read_b64_tr_b16 v[242:243], v253 offset:58368
    s_waitcnt lgkmcnt(12)
    v_mfma_f32_16x16x32_bf16 v[32:35], v[216:219], v[176:179], v[32:35]
    ds_read_b64_tr_b16 v[244:245], v254 offset:57344
    v_mfma_f32_16x16x32_bf16 v[60:63], v[216:219], v[180:183], v[60:63]
    ds_read_b64_tr_b16 v[246:247], v254 offset:58368
    s_waitcnt vmcnt(0)
    s_waitcnt lgkmcnt(12)
    v_mfma_f32_16x16x32_bf16 v[8:11], v[220:223], v[184:187], v[8:11]
    v_mfma_f32_16x16x32_bf16 v[36:39], v[220:223], v[188:191], v[36:39]
    s_waitcnt lgkmcnt(10)
    v_mfma_f32_16x16x32_bf16 v[12:15], v[224:227], v[184:187], v[12:15]
    v_mfma_f32_16x16x32_bf16 v[40:43], v[224:227], v[188:191], v[40:43]
    s_waitcnt lgkmcnt(8)
    v_mfma_f32_16x16x32_bf16 v[16:19], v[228:231], v[184:187], v[16:19]
    v_mfma_f32_16x16x32_bf16 v[44:47], v[228:231], v[188:191], v[44:47]
    s_waitcnt lgkmcnt(6)
    v_mfma_f32_16x16x32_bf16 v[20:23], v[232:235], v[184:187], v[20:23]
    v_mfma_f32_16x16x32_bf16 v[48:51], v[232:235], v[188:191], v[48:51]
    s_waitcnt lgkmcnt(4)
    v_mfma_f32_16x16x32_bf16 v[24:27], v[236:239], v[184:187], v[24:27]
    v_mfma_f32_16x16x32_bf16 v[52:55], v[236:239], v[188:191], v[52:55]
    s_waitcnt lgkmcnt(2)
    v_mfma_f32_16x16x32_bf16 v[28:31], v[240:243], v[184:187], v[28:31]
    v_mfma_f32_16x16x32_bf16 v[56:59], v[240:243], v[188:191], v[56:59]
    s_waitcnt lgkmcnt(0)
    v_mfma_f32_16x16x32_bf16 v[32:35], v[244:247], v[184:187], v[32:35]
    v_mfma_f32_16x16x32_bf16 v[60:63], v[244:247], v[188:191], v[60:63]
    v_mov_b32 v4, 162880
    v_mov_b32 v5, 1
    s_mov_b64 exec, 1
    ds_add_u32 v4, v5 offset:36
    s_mov_b64 exec, -1
    v_and_b32 v4, 1, v2
    v_lshlrev_b32 v4, 9, v4
    v_lshrrev_b32 v5, 1, v2
    v_lshl_add_u32 v4, v5, 8, v4
    v_lshl_add_u32 v4, v3, 4, v4
    s_and_b32 s60, s55, 1
    v_lshlrev_b32 v6, 8, v5
    v_lshl_add_u32 v6, v3, 4, v6
    v_and_b32 v5, 1, v2
    v_mul_u32_u24 v5, 57344, v5
    v_add_u32 v6, v6, v5
    s_mul_i32 s52, s55, 7
    s_add_u32 s57, s52, s60
    s_lshr_b32 s57, s57, 1
    s_lshl_b32 s57, s57, 10
    s_mul_i32 s53, s56, 57344
    s_add_u32 s57, s57, s53
    s_add_u32 s58, s57, 57344
    s_lshr_b32 s59, s52, 1
    s_cmp_eq_u32 s60, 0
    s_cselect_b32 s61, 3, 0
    s_add_u32 s59, s59, s61
    s_lshl_b32 s59, s59, 10
    s_add_u32 s59, s59, s53
    s_lshl_b32 s60, s60, 9
    s_add_u32 s59, s59, s60
    v_cvt_pk_bf16_f32 v64, v8, v9
    v_cvt_pk_bf16_f32 v65, v10, v11
    v_pk_max_i16 v64, v64, 0
    v_pk_max_i16 v65, v65, 0
    v_cvt_pk_bf16_f32 v66, v12, v13
    v_cvt_pk_bf16_f32 v67, v14, v15
    v_pk_max_i16 v66, v66, 0
    v_pk_max_i16 v67, v67, 0
    s_nop 0
    v_permlane16_swap_b32 v64, v66
    v_permlane16_swap_b32 v65, v67
    buffer_store_dwordx4 v[64:67], v4, s[44:47], s57 offen offset:0 sc1
    v_cvt_pk_bf16_f32 v68, v16, v17
    v_cvt_pk_bf16_f32 v69, v18, v19
    v_pk_max_i16 v68, v68, 0
    v_pk_max_i16 v69, v69, 0
    v_cvt_pk_bf16_f32 v70, v20, v21
    v_cvt_pk_bf16_f32 v71, v22, v23
    v_pk_max_i16 v70, v70, 0
    v_pk_max_i16 v71, v71, 0
    s_nop 0
    v_permlane16_swap_b32 v68, v70
    v_permlane16_swap_b32 v69, v71
    buffer_store_dwordx4 v[68:71], v4, s[44:47], s57 offen offset:1024 sc1
    v_cvt_pk_bf16_f32 v72, v24, v25
    v_cvt_pk_bf16_f32 v73, v26, v27
    v_pk_max_i16 v72, v72, 0
    v_pk_max_i16 v73, v73, 0
    v_cvt_pk_bf16_f32 v74, v28, v29
    v_cvt_pk_bf16_f32 v75, v30, v31
    v_pk_max_i16 v74, v74, 0
    v_pk_max_i16 v75, v75, 0
    s_nop 0
    v_permlane16_swap_b32 v72, v74
    v_permlane16_swap_b32 v73, v75
    buffer_store_dwordx4 v[72:75], v4, s[44:47], s57 offen offset:2048 sc1
    v_cvt_pk_bf16_f32 v88, v32, v33
    v_cvt_pk_bf16_f32 v89, v34, v35
    v_pk_max_i16 v88, v88, 0
    v_pk_max_i16 v89, v89, 0
    v_cvt_pk_bf16_f32 v76, v36, v37
    v_cvt_pk_bf16_f32 v77, v38, v39
    v_pk_max_i16 v76, v76, 0
    v_pk_max_i16 v77, v77, 0
    v_cvt_pk_bf16_f32 v78, v40, v41
    v_cvt_pk_bf16_f32 v79, v42, v43
    v_pk_max_i16 v78, v78, 0
    v_pk_max_i16 v79, v79, 0
    s_nop 0
    v_permlane16_swap_b32 v76, v78
    v_permlane16_swap_b32 v77, v79
    buffer_store_dwordx4 v[76:79], v4, s[44:47], s58 offen offset:0 sc1
    v_cvt_pk_bf16_f32 v80, v44, v45
    v_cvt_pk_bf16_f32 v81, v46, v47
    v_pk_max_i16 v80, v80, 0
    v_pk_max_i16 v81, v81, 0
    v_cvt_pk_bf16_f32 v82, v48, v49
    v_cvt_pk_bf16_f32 v83, v50, v51
    v_pk_max_i16 v82, v82, 0
    v_pk_max_i16 v83, v83, 0
    s_nop 0
    v_permlane16_swap_b32 v80, v82
    v_permlane16_swap_b32 v81, v83
    buffer_store_dwordx4 v[80:83], v4, s[44:47], s58 offen offset:1024 sc1
    v_cvt_pk_bf16_f32 v84, v52, v53
    v_cvt_pk_bf16_f32 v85, v54, v55
    v_pk_max_i16 v84, v84, 0
    v_pk_max_i16 v85, v85, 0
    v_cvt_pk_bf16_f32 v86, v56, v57
    v_cvt_pk_bf16_f32 v87, v58, v59
    v_pk_max_i16 v86, v86, 0
    v_pk_max_i16 v87, v87, 0
    s_nop 0
    v_permlane16_swap_b32 v84, v86
    v_permlane16_swap_b32 v85, v87
    buffer_store_dwordx4 v[84:87], v4, s[44:47], s58 offen offset:2048 sc1
    v_cvt_pk_bf16_f32 v90, v60, v61
    v_cvt_pk_bf16_f32 v91, v62, v63
    v_pk_max_i16 v90, v90, 0
    v_pk_max_i16 v91, v91, 0
    s_nop 0
    v_permlane16_swap_b32 v88, v90
    v_permlane16_swap_b32 v89, v91
    buffer_store_dwordx4 v[88:91], v6, s[44:47], s59 offen sc1
P3_STD:
    s_and_b32 s56, s55, 1
    s_lshl_b32 s56, s56, 2
    s_lshl_b32 s52, s54, 3
    s_add_u32 s56, s56, s52
    s_lshr_b32 s55, s55, 1
    s_waitcnt vmcnt(0)
    s_cmp_eq_u32 s25, 0
    s_cbranch_scc1 S3_SLOW
    s_mov_b32 s48, s6
    s_mov_b32 s49, s7
    s_mov_b32 s50, 65536
    s_mov_b32 s51, 0x20000
    v_mov_b32 v12, 162880
    v_mov_b32 v13, 1
    s_mov_b64 exec, 1
    ds_add_rtn_u32 v14, v12, v13 offset:40
    s_waitcnt lgkmcnt(0)
    v_readfirstlane_b32 s27, v14
    s_lshl_b32 s52, s54, 7
    s_add_u32 s52, s52, 38912
    s_cmp_lg_u32 s27, 3
    s_cbranch_scc1 S3_FA
    s_and_b32 s53, s23, 1
    s_lshr_b32 s63, s23, 2
    s_lshl_b32 s63, s63, 1
    s_add_u32 s53, s53, s63
    s_lshl_b32 s53, s53, 2
    v_mov_b32 v14, s53
    v_mov_b32 v13, s26
    buffer_store_dword v13, v14, s[48:51], s52 offen
S3_FA:
    s_mov_b64 exec, -1
    s_mov_b32 s63, s52
    v_lshlrev_b32 v7, 4, v1
    s_mul_i32 s57, s56, 57344
    s_mul_i32 s52, s21, 14336
    s_add_u32 s57, s57, s52
    s_add_u32 s58, s21, 1
    s_and_b32 s58, s58, 3
    s_mul_i32 s58, s58, 57344
    s_add_u32 s58, s58, s57
    s_add_u32 s59, s21, 2
    s_and_b32 s59, s59, 3
    s_mul_i32 s59, s59, 57344
    s_add_u32 s59, s59, s57
    s_add_u32 s60, s21, 3
    s_and_b32 s60, s60, 3
    s_mul_i32 s60, s60, 57344
    s_add_u32 s60, s60, s57
    s_mul_i32 s52, s21, 57344
    s_add_u32 s57, s57, s52
    v_lshrrev_b32 v4, 3, v1
    v_and_b32 v5, 7, v1
    v_bfe_u32 v6, v1, 4, 1
    v_lshlrev_b32 v6, 1, v6
    v_xor_b32 v8, v5, v6
    v_xor_b32 v9, 4, v8
    v_lshlrev_b32 v4, 10, v4
    s_lshl_b32 s52, s55, 7
    v_add_u32 v4, s52, v4
    v_lshl_add_u32 v5, v8, 4, v4
    v_lshl_add_u32 v6, v9, 4, v4
    s_mul_i32 s61, s21, 458752
    s_add_u32 s61, s61, 294912
    s_mul_i32 s62, s21, 36864
    v_bfe_u32 v9, v1, 2, 2
    v_bfe_u32 v10, v1, 3, 1
    v_and_b32 v11, 1, v2
    v_lshl_add_u32 v10, v11, 1, v10
    v_lshlrev_b32 v10, 1, v10
    v_lshl_add_u32 v9, v2, 3, v9
    v_lshlrev_b32 v9, 7, v9
    v_bfe_u32 v11, v1, 1, 1
    v_lshl_add_u32 v9, v11, 4, v9
    v_and_b32 v11, 1, v1
    v_lshl_add_u32 v9, v11, 3, v9
    v_add_u32 v9, s62, v9
    v_xor_b32 v11, 0, v10
    v_lshl_add_u32 v252, v11, 4, v9
    v_xor_b32 v11, 2, v10
    v_lshl_add_u32 v253, v11, 4, v9
    v_xor_b32 v11, 4, v10
    v_lshl_add_u32 v254, v11, 4, v9
    v_xor_b32 v11, 6, v10
    v_lshl_add_u32 v255, v11, 4, v9
    s_mov_b32 s28, s10
    s_mov_b32 s29, s11
    s_mov_b32 s30, 1835008
    s_mov_b32 s31, 0x20000
    s_cmp_eq_u32 s25, 0
    s_cselect_b32 s27, 0, 0
    s_add_u32 s40, s6, s27
    s_addc_u32 s41, s7, 0
    s_add_u32 s40, s40, 2162688
    s_addc_u32 s41, s41, 0
    s_mov_b32 s42, 2097152
    s_mov_b32 s43, 0x20000
    v_and_b32 v9, 1, v2
    v_lshlrev_b32 v9, 1, v9
    v_lshrrev_b32 v10, 1, v2
    v_add_u32 v9, v9, v10
    v_lshlrev_b32 v248, 8, v9
    v_lshl_add_u32 v248, v3, 4, v248
    v_lshlrev_b32 v249, 4, v9
    v_mov_b32 v250, 162880
    v_mov_b32 v251, 1
LW10:
    ds_read_b32 v11, v250 offset:48
    s_waitcnt lgkmcnt(0)
    v_readfirstlane_b32 s27, v11
    s_cmp_eq_u32 s24, 0
    s_cbranch_scc1 LW10_X
    s_sub_u32 s24, s24, 1
    s_cmp_lt_u32 s27, 4
    s_cbranch_scc1 LW10
LW10_X:
    ds_read_b64_tr_b16 v[104:105], v252 offset:0
    ds_read_b64_tr_b16 v[106:107], v252 offset:512
    ds_read_b64_tr_b16 v[108:109], v253 offset:0
    ds_read_b64_tr_b16 v[110:111], v253 offset:512
    ds_read_b64_tr_b16 v[112:113], v254 offset:0
    ds_read_b64_tr_b16 v[114:115], v254 offset:512
    ds_read_b64_tr_b16 v[116:117], v255 offset:0
    ds_read_b64_tr_b16 v[118:119], v255 offset:512
    s_waitcnt lgkmcnt(8)
    ds_read_b64_tr_b16 v[120:121], v252 offset:4096
    ds_read_b64_tr_b16 v[122:123], v252 offset:4608
    ds_read_b64_tr_b16 v[124:125], v253 offset:4096
    ds_read_b64_tr_b16 v[126:127], v253 offset:4608
    ds_read_b64_tr_b16 v[128:129], v254 offset:4096
    ds_read_b64_tr_b16 v[130:131], v254 offset:4608
    ds_read_b64_tr_b16 v[132:133], v255 offset:4096
    ds_read_b64_tr_b16 v[134:135], v255 offset:4608
    s_waitcnt lgkmcnt(8)
    ds_read_b64_tr_b16 v[136:137], v252 offset:8192
    ds_read_b64_tr_b16 v[138:139], v252 offset:8704
    ds_read_b64_tr_b16 v[140:141], v253 offset:8192
    ds_read_b64_tr_b16 v[142:143], v253 offset:8704
    ds_read_b64_tr_b16 v[144:145], v254 offset:8192
    ds_read_b64_tr_b16 v[146:147], v254 offset:8704
    ds_read_b64_tr_b16 v[148:149], v255 offset:8192
    ds_read_b64_tr_b16 v[150:151], v255 offset:8704
    s_waitcnt lgkmcnt(8)
    ds_read_b64_tr_b16 v[152:153], v252 offset:12288
    ds_read_b64_tr_b16 v[154:155], v252 offset:12800
    ds_read_b64_tr_b16 v[156:157], v253 offset:12288
    ds_read_b64_tr_b16 v[158:159], v253 offset:12800
    ds_read_b64_tr_b16 v[160:161], v254 offset:12288
    ds_read_b64_tr_b16 v[162:163], v254 offset:12800
    ds_read_b64_tr_b16 v[164:165], v255 offset:12288
    ds_read_b64_tr_b16 v[166:167], v255 offset:12800
    s_waitcnt lgkmcnt(8)
    ds_read_b64_tr_b16 v[168:169], v252 offset:16384
    ds_read_b64_tr_b16 v[170:171], v252 offset:16896
    ds_read_b64_tr_b16 v[172:173], v253 offset:16384
    ds_read_b64_tr_b16 v[174:175], v253 offset:16896
    ds_read_b64_tr_b16 v[176:177], v254 offset:16384
    ds_read_b64_tr_b16 v[178:179], v254 offset:16896
    ds_read_b64_tr_b16 v[180:181], v255 offset:16384
    ds_read_b64_tr_b16 v[182:183], v255 offset:16896
    s_waitcnt lgkmcnt(8)
    s_waitcnt lgkmcnt(0)
    s_mov_b64 exec, 1
    ds_add_u32 v250, v251 offset:100
    s_mov_b64 exec, -1
    s_cmp_lg_u32 s20, 0
    s_cbranch_scc1 S3_FW
    v_lshlrev_b32 v13, 2, v1
    s_mov_b64 exec, 0xffff
S3_FP:
    buffer_load_dword v14, v13, s[48:51], s63 offen sc1
    s_waitcnt vmcnt(0)
    s_cmp_eq_u32 s24, 0
    s_cbranch_scc1 S3_FX
    s_sub_u32 s24, s24, 1
    v_cmp_ne_u32 vcc, s26, v14
    s_cbranch_vccnz S3_FP
S3_FX:
    s_mov_b64 exec, 1
    v_mov_b32 v12, 162880
    v_mov_b32 v13, 1
    ds_write_b32 v12, v13 offset:44
    s_mov_b64 exec, -1
    s_branch S3_DONE
S3_FW:
    v_mov_b32 v12, 162880
LW11:
    ds_read_b32 v14, v12 offset:44
    s_waitcnt lgkmcnt(0)
    v_readfirstlane_b32 s27, v14
    s_cmp_eq_u32 s24, 0
    s_cbranch_scc1 LW11_X
    s_sub_u32 s24, s24, 1
    s_cmp_lt_u32 s27, 1
    s_cbranch_scc1 LW11
LW11_X:
    s_branch S3_DONE
S3_SLOW:
    s_add_u32 s48, s6, 16384
    s_addc_u32 s49, s7, 0
    s_mov_b32 s50, 11264
    s_mov_b32 s51, 0x20000
    v_mov_b32 v12, 162880
    v_mov_b32 v13, 1
    s_mov_b64 exec, 1
    ds_add_rtn_u32 v14, v12, v13 offset:40
    s_waitcnt lgkmcnt(0)
    v_readfirstlane_b32 s27, v14
    s_cmp_lg_u32 s27, 3
    s_cbranch_scc1 S3_A
    s_lshl_b32 s52, s54, 7
    s_add_u32 s52, s52, 7168
    v_mov_b32 v14, s52
    buffer_atomic_add v13, v14, s[48:51], 0 offen
S3_A:
    s_mov_b64 exec, -1
    v_lshlrev_b32 v7, 4, v1
    s_mul_i32 s57, s56, 57344
    s_mul_i32 s52, s21, 14336
    s_add_u32 s57, s57, s52
    s_add_u32 s58, s21, 1
    s_and_b32 s58, s58, 3
    s_mul_i32 s58, s58, 57344
    s_add_u32 s58, s58, s57
    s_add_u32 s59, s21, 2
    s_and_b32 s59, s59, 3
    s_mul_i32 s59, s59, 57344
    s_add_u32 s59, s59, s57
    s_add_u32 s60, s21, 3
    s_and_b32 s60, s60, 3
    s_mul_i32 s60, s60, 57344
    s_add_u32 s60, s60, s57
    s_mul_i32 s52, s21, 57344
    s_add_u32 s57, s57, s52
    v_lshrrev_b32 v4, 3, v1
    v_and_b32 v5, 7, v1
    v_bfe_u32 v6, v1, 4, 1
    v_lshlrev_b32 v6, 1, v6
    v_xor_b32 v8, v5, v6
    v_xor_b32 v9, 4, v8
    v_lshlrev_b32 v4, 10, v4
    s_lshl_b32 s52, s55, 7
    v_add_u32 v4, s52, v4
    v_lshl_add_u32 v5, v8, 4, v4
    v_lshl_add_u32 v6, v9, 4, v4
    s_mul_i32 s61, s21, 458752
    s_add_u32 s61, s61, 294912
    s_mul_i32 s62, s21, 36864
    v_bfe_u32 v9, v1, 2, 2
    v_bfe_u32 v10, v1, 3, 1
    v_and_b32 v11, 1, v2
    v_lshl_add_u32 v10, v11, 1, v10
    v_lshlrev_b32 v10, 1, v10
    v_lshl_add_u32 v9, v2, 3, v9
    v_lshlrev_b32 v9, 7, v9
    v_bfe_u32 v11, v1, 1, 1
    v_lshl_add_u32 v9, v11, 4, v9
    v_and_b32 v11, 1, v1
    v_lshl_add_u32 v9, v11, 3, v9
    v_add_u32 v9, s62, v9
    v_xor_b32 v11, 0, v10
    v_lshl_add_u32 v252, v11, 4, v9
    v_xor_b32 v11, 2, v10
    v_lshl_add_u32 v253, v11, 4, v9
    v_xor_b32 v11, 4, v10
    v_lshl_add_u32 v254, v11, 4, v9
    v_xor_b32 v11, 6, v10
    v_lshl_add_u32 v255, v11, 4, v9
    s_mov_b32 s28, s10
    s_mov_b32 s29, s11
    s_mov_b32 s30, 1835008
    s_mov_b32 s31, 0x20000
    s_cmp_eq_u32 s25, 0
    s_cselect_b32 s27, 0, 0
    s_add_u32 s40, s6, s27
    s_addc_u32 s41, s7, 0
    s_add_u32 s40, s40, 2162688
    s_addc_u32 s41, s41, 0
    s_mov_b32 s42, 2097152
    s_mov_b32 s43, 0x20000
    v_and_b32 v9, 1, v2
    v_lshlrev_b32 v9, 1, v9
    v_lshrrev_b32 v10, 1, v2
    v_add_u32 v9, v9, v10
    v_lshlrev_b32 v248, 8, v9
    v_lshl_add_u32 v248, v3, 4, v248
    v_lshlrev_b32 v249, 4, v9
    v_mov_b32 v250, 162880
    v_mov_b32 v251, 1
LW12:
    ds_read_b32 v11, v250 offset:48
    s_waitcnt lgkmcnt(0)
    v_readfirstlane_b32 s27, v11
    s_cmp_eq_u32 s24, 0
    s_cbranch_scc1 LW12_X
    s_sub_u32 s24, s24, 1
    s_cmp_lt_u32 s27, 4
    s_cbranch_scc1 LW12
LW12_X:
    ds_read_b64_tr_b16 v[104:105], v252 offset:0
    ds_read_b64_tr_b16 v[106:107], v252 offset:512
    ds_read_b64_tr_b16 v[108:109], v253 offset:0
    ds_read_b64_tr_b16 v[110:111], v253 offset:512
    ds_read_b64_tr_b16 v[112:113], v254 offset:0
    ds_read_b64_tr_b16 v[114:115], v254 offset:512
    ds_read_b64_tr_b16 v[116:117], v255 offset:0
    ds_read_b64_tr_b16 v[118:119], v255 offset:512
    s_waitcnt lgkmcnt(8)
    ds_read_b64_tr_b16 v[120:121], v252 offset:4096
    ds_read_b64_tr_b16 v[122:123], v252 offset:4608
    ds_read_b64_tr_b16 v[124:125], v253 offset:4096
    ds_read_b64_tr_b16 v[126:127], v253 offset:4608
    ds_read_b64_tr_b16 v[128:129], v254 offset:4096
    ds_read_b64_tr_b16 v[130:131], v254 offset:4608
    ds_read_b64_tr_b16 v[132:133], v255 offset:4096
    ds_read_b64_tr_b16 v[134:135], v255 offset:4608
    s_waitcnt lgkmcnt(8)
    ds_read_b64_tr_b16 v[136:137], v252 offset:8192
    ds_read_b64_tr_b16 v[138:139], v252 offset:8704
    ds_read_b64_tr_b16 v[140:141], v253 offset:8192
    ds_read_b64_tr_b16 v[142:143], v253 offset:8704
    ds_read_b64_tr_b16 v[144:145], v254 offset:8192
    ds_read_b64_tr_b16 v[146:147], v254 offset:8704
    ds_read_b64_tr_b16 v[148:149], v255 offset:8192
    ds_read_b64_tr_b16 v[150:151], v255 offset:8704
    s_waitcnt lgkmcnt(8)
    ds_read_b64_tr_b16 v[152:153], v252 offset:12288
    ds_read_b64_tr_b16 v[154:155], v252 offset:12800
    ds_read_b64_tr_b16 v[156:157], v253 offset:12288
    ds_read_b64_tr_b16 v[158:159], v253 offset:12800
    ds_read_b64_tr_b16 v[160:161], v254 offset:12288
    ds_read_b64_tr_b16 v[162:163], v254 offset:12800
    ds_read_b64_tr_b16 v[164:165], v255 offset:12288
    ds_read_b64_tr_b16 v[166:167], v255 offset:12800
    s_waitcnt lgkmcnt(8)
    ds_read_b64_tr_b16 v[168:169], v252 offset:16384
    ds_read_b64_tr_b16 v[170:171], v252 offset:16896
    ds_read_b64_tr_b16 v[172:173], v253 offset:16384
    ds_read_b64_tr_b16 v[174:175], v253 offset:16896
    ds_read_b64_tr_b16 v[176:177], v254 offset:16384
    ds_read_b64_tr_b16 v[178:179], v254 offset:16896
    ds_read_b64_tr_b16 v[180:181], v255 offset:16384
    ds_read_b64_tr_b16 v[182:183], v255 offset:16896
    s_waitcnt lgkmcnt(8)
    s_waitcnt lgkmcnt(0)
    s_mov_b64 exec, 1
    ds_add_u32 v250, v251 offset:100
    s_mov_b64 exec, -1
    s_cmp_lg_u32 s20, 0
    s_cbranch_scc1 S3_W
    s_and_b32 s52, s23, 29
    s_cmp_eq_u32 s52, 0
    s_cbranch_scc0 S3_O
    s_lshl_b32 s52, s54, 7
    s_add_u32 s52, s52, 7168
    v_mov_b32 v13, s52
    s_mov_b64 exec, 0x1
    s_mov_b32 s100, 0
S3_P:
    s_add_u32 s100, s100, 1
    s_and_b32 s101, s100, 1023
    s_cmp_eq_u32 s101, 0
    s_cbranch_scc1 S3_P_AT
    buffer_load_dword v14, v13, s[48:51], 0 offen sc1
    s_branch S3_P_WT
S3_P_AT:
    v_mov_b32 v14, 0
    buffer_atomic_add v14, v13, s[48:51], 0 offen sc0
S3_P_WT:
    s_waitcnt vmcnt(0)
    s_cmp_eq_u32 s24, 0
    s_cbranch_scc1 S3_R
    s_sub_u32 s24, s24, 1
    v_cmp_gt_u32 vcc, 16, v14
    s_cbranch_vccnz S3_P
S3_R:
    s_mov_b64 exec, 0x1
    s_lshl_b32 s52, s54, 7
    s_add_u32 s52, s52, 9216
    v_mov_b32 v13, s52
    v_mov_b32 v14, s26
    buffer_store_dword v14, v13, s[48:51], 0 offen sc1
    s_branch S3_X
S3_O:
    s_lshl_b32 s52, s54, 7
    s_add_u32 s52, s52, 9216
    v_mov_b32 v13, s52
    s_mov_b64 exec, 1
    s_mov_b32 s100, 0
S3_Q:
    s_add_u32 s100, s100, 1
    s_and_b32 s101, s100, 1023
    s_cmp_eq_u32 s101, 0
    s_cbranch_scc1 S3_Q_AT
    buffer_load_dword v14, v13, s[48:51], 0 offen sc1
    s_branch S3_Q_WT
S3_Q_AT:
    v_mov_b32 v14, 0
    buffer_atomic_add v14, v13, s[48:51], 0 offen sc0
S3_Q_WT:
    s_waitcnt vmcnt(0)
    v_readfirstlane_b32 s27, v14
    s_cmp_eq_u32 s24, 0
    s_cbranch_scc1 S3_X
    s_sub_u32 s24, s24, 1
    s_cmp_lg_u32 s27, s26
    s_cbranch_scc1 S3_Q
S3_X:
    s_mov_b64 exec, 1
    v_mov_b32 v12, 162880
    v_mov_b32 v13, 1
    ds_write_b32 v12, v13 offset:44
    s_mov_b64 exec, -1
    s_branch S3_D
S3_W:
    v_mov_b32 v12, 162880
LW13:
    ds_read_b32 v14, v12 offset:44
    s_waitcnt lgkmcnt(0)
    v_readfirstlane_b32 s27, v14
    s_cmp_eq_u32 s24, 0
    s_cbranch_scc1 LW13_X
    s_sub_u32 s24, s24, 1
    s_cmp_lt_u32 s27, 1
    s_cbranch_scc1 LW13
LW13_X:
S3_D:
S3_DONE:
    buffer_load_dwordx4 v[184:187], v7, s[44:47], s57 offen offset:0 sc1
    buffer_load_dwordx4 v[188:191], v7, s[44:47], s58 offen offset:0 sc1
    buffer_load_dwordx4 v[192:195], v7, s[44:47], s59 offen offset:0 sc1
    buffer_load_dwordx4 v[196:199], v7, s[44:47], s60 offen offset:0 sc1
    buffer_load_dwordx4 v[200:203], v7, s[44:47], s57 offen offset:1024 sc1
    buffer_load_dwordx4 v[204:207], v7, s[44:47], s58 offen offset:1024 sc1
    buffer_load_dwordx4 v[208:211], v7, s[44:47], s59 offen offset:1024 sc1
    buffer_load_dwordx4 v[212:215], v7, s[44:47], s60 offen offset:1024 sc1
    buffer_load_dwordx4 v[216:219], v7, s[44:47], s57 offen offset:2048 sc1
    buffer_load_dwordx4 v[220:223], v7, s[44:47], s58 offen offset:2048 sc1
    buffer_load_dwordx4 v[224:227], v7, s[44:47], s59 offen offset:2048 sc1
    buffer_load_dwordx4 v[228:231], v7, s[44:47], s60 offen offset:2048 sc1
    buffer_load_dwordx4 v[232:235], v7, s[44:47], s57 offen offset:3072 sc1
    buffer_load_dwordx4 v[236:239], v7, s[44:47], s58 offen offset:3072 sc1
    buffer_load_dwordx4 v[240:243], v7, s[44:47], s59 offen offset:3072 sc1
    buffer_load_dwordx4 v[244:247], v7, s[44:47], s60 offen offset:3072 sc1
    s_add_u32 s57, s57, 4096
    s_add_u32 s58, s58, 4096
    s_add_u32 s59, s59, 4096
    s_add_u32 s60, s60, 4096
    s_waitcnt vmcnt(12)
    v_mfma_f32_16x16x32_bf16 v[8:11], v[104:107], v[184:187], 0
    v_mfma_f32_16x16x32_bf16 v[24:27], v[104:107], v[188:191], 0
    v_mfma_f32_16x16x32_bf16 v[40:43], v[104:107], v[192:195], 0
    v_mfma_f32_16x16x32_bf16 v[56:59], v[104:107], v[196:199], 0
    v_mfma_f32_16x16x32_bf16 v[12:15], v[108:111], v[184:187], 0
    v_mfma_f32_16x16x32_bf16 v[28:31], v[108:111], v[188:191], 0
    v_mfma_f32_16x16x32_bf16 v[44:47], v[108:111], v[192:195], 0
    v_mfma_f32_16x16x32_bf16 v[60:63], v[108:111], v[196:199], 0
    v_mfma_f32_16x16x32_bf16 v[16:19], v[112:115], v[184:187], 0
    v_mfma_f32_16x16x32_bf16 v[32:35], v[112:115], v[188:191], 0
    v_mfma_f32_16x16x32_bf16 v[48:51], v[112:115], v[192:195], 0
    v_mfma_f32_16x16x32_bf16 v[64:67], v[112:115], v[196:199], 0
    v_mfma_f32_16x16x32_bf16 v[20:23], v[116:119], v[184:187], 0
    v_mfma_f32_16x16x32_bf16 v[36:39], v[116:119], v[188:191], 0
    v_mfma_f32_16x16x32_bf16 v[52:55], v[116:119], v[192:195], 0
    v_mfma_f32_16x16x32_bf16 v[68:71], v[116:119], v[196:199], 0
    s_waitcnt vmcnt(8)
    v_mfma_f32_16x16x32_bf16 v[8:11], v[120:123], v[200:203], v[8:11]
    buffer_load_dwordx4 v[184:187], v7, s[44:47], s57 offen offset:0 sc1
    v_mfma_f32_16x16x32_bf16 v[24:27], v[120:123], v[204:207], v[24:27]
    buffer_load_dwordx4 v[188:191], v7, s[44:47], s58 offen offset:0 sc1
    v_mfma_f32_16x16x32_bf16 v[40:43], v[120:123], v[208:211], v[40:43]
    buffer_load_dwordx4 v[192:195], v7, s[44:47], s59 offen offset:0 sc1
    v_mfma_f32_16x16x32_bf16 v[56:59], v[120:123], v[212:215], v[56:59]
    buffer_load_dwordx4 v[196:199], v7, s[44:47], s60 offen offset:0 sc1
    v_mfma_f32_16x16x32_bf16 v[12:15], v[124:127], v[200:203], v[12:15]
    v_mfma_f32_16x16x32_bf16 v[28:31], v[124:127], v[204:207], v[28:31]
    v_mfma_f32_16x16x32_bf16 v[44:47], v[124:127], v[208:211], v[44:47]
    v_mfma_f32_16x16x32_bf16 v[60:63], v[124:127], v[212:215], v[60:63]
    v_mfma_f32_16x16x32_bf16 v[16:19], v[128:131], v[200:203], v[16:19]
    v_mfma_f32_16x16x32_bf16 v[32:35], v[128:131], v[204:207], v[32:35]
    v_mfma_f32_16x16x32_bf16 v[48:51], v[128:131], v[208:211], v[48:51]
    v_mfma_f32_16x16x32_bf16 v[64:67], v[128:131], v[212:215], v[64:67]
    v_mfma_f32_16x16x32_bf16 v[20:23], v[132:135], v[200:203], v[20:23]
    v_mfma_f32_16x16x32_bf16 v[36:39], v[132:135], v[204:207], v[36:39]
    v_mfma_f32_16x16x32_bf16 v[52:55], v[132:135], v[208:211], v[52:55]
    v_mfma_f32_16x16x32_bf16 v[68:71], v[132:135], v[212:215], v[68:71]
    s_waitcnt vmcnt(8)
    v_mfma_f32_16x16x32_bf16 v[8:11], v[136:139], v[216:219], v[8:11]
    buffer_load_dwordx4 v[200:203], v7, s[44:47], s57 offen offset:1024 sc1
    v_mfma_f32_16x16x32_bf16 v[24:27], v[136:139], v[220:223], v[24:27]
    buffer_load_dwordx4 v[204:207], v7, s[44:47], s58 offen offset:1024 sc1
    v_mfma_f32_16x16x32_bf16 v[40:43], v[136:139], v[224:227], v[40:43]
    buffer_load_dwordx4 v[208:211], v7, s[44:47], s59 offen offset:1024 sc1
    v_mfma_f32_16x16x32_bf16 v[56:59], v[136:139], v[228:231], v[56:59]
    buffer_load_dwordx4 v[212:215], v7, s[44:47], s60 offen offset:1024 sc1
    v_mfma_f32_16x16x32_bf16 v[12:15], v[140:143], v[216:219], v[12:15]
    v_mfma_f32_16x16x32_bf16 v[28:31], v[140:143], v[220:223], v[28:31]
    v_mfma_f32_16x16x32_bf16 v[44:47], v[140:143], v[224:227], v[44:47]
    v_mfma_f32_16x16x32_bf16 v[60:63], v[140:143], v[228:231], v[60:63]
    v_mfma_f32_16x16x32_bf16 v[16:19], v[144:147], v[216:219], v[16:19]
    v_mfma_f32_16x16x32_bf16 v[32:35], v[144:147], v[220:223], v[32:35]
    v_mfma_f32_16x16x32_bf16 v[48:51], v[144:147], v[224:227], v[48:51]
    v_mfma_f32_16x16x32_bf16 v[64:67], v[144:147], v[228:231], v[64:67]
    v_mfma_f32_16x16x32_bf16 v[20:23], v[148:151], v[216:219], v[20:23]
    v_mfma_f32_16x16x32_bf16 v[36:39], v[148:151], v[220:223], v[36:39]
    v_mfma_f32_16x16x32_bf16 v[52:55], v[148:151], v[224:227], v[52:55]
    v_mfma_f32_16x16x32_bf16 v[68:71], v[148:151], v[228:231], v[68:71]
    s_waitcnt vmcnt(8)
    v_mfma_f32_16x16x32_bf16 v[8:11], v[152:155], v[232:235], v[8:11]
    buffer_load_dwordx4 v[216:219], v7, s[44:47], s57 offen offset:2048 sc1
    v_mfma_f32_16x16x32_bf16 v[24:27], v[152:155], v[236:239], v[24:27]
    buffer_load_dwordx4 v[220:223], v7, s[44:47], s58 offen offset:2048 sc1
    v_mfma_f32_16x16x32_bf16 v[40:43], v[152:155], v[240:243], v[40:43]
    buffer_load_dwordx4 v[224:227], v7, s[44:47], s59 offen offset:2048 sc1
    v_mfma_f32_16x16x32_bf16 v[56:59], v[152:155], v[244:247], v[56:59]
    buffer_load_dwordx4 v[228:231], v7, s[44:47], s60 offen offset:2048 sc1
    v_mfma_f32_16x16x32_bf16 v[12:15], v[156:159], v[232:235], v[12:15]
    v_mfma_f32_16x16x32_bf16 v[28:31], v[156:159], v[236:239], v[28:31]
    v_mfma_f32_16x16x32_bf16 v[44:47], v[156:159], v[240:243], v[44:47]
    v_mfma_f32_16x16x32_bf16 v[60:63], v[156:159], v[244:247], v[60:63]
    v_mfma_f32_16x16x32_bf16 v[16:19], v[160:163], v[232:235], v[16:19]
    v_mfma_f32_16x16x32_bf16 v[32:35], v[160:163], v[236:239], v[32:35]
    v_mfma_f32_16x16x32_bf16 v[48:51], v[160:163], v[240:243], v[48:51]
    v_mfma_f32_16x16x32_bf16 v[64:67], v[160:163], v[244:247], v[64:67]
    v_mfma_f32_16x16x32_bf16 v[20:23], v[164:167], v[232:235], v[20:23]
    v_mfma_f32_16x16x32_bf16 v[36:39], v[164:167], v[236:239], v[36:39]
    v_mfma_f32_16x16x32_bf16 v[52:55], v[164:167], v[240:243], v[52:55]
    v_mfma_f32_16x16x32_bf16 v[68:71], v[164:167], v[244:247], v[68:71]
    s_waitcnt vmcnt(8)
    v_mfma_f32_16x16x32_bf16 v[8:11], v[168:171], v[184:187], v[8:11]
    ds_read_b64_tr_b16 v[88:89], v252 offset:20480
    v_mfma_f32_16x16x32_bf16 v[24:27], v[168:171], v[188:191], v[24:27]
    ds_read_b64_tr_b16 v[90:91], v252 offset:20992
    v_mfma_f32_16x16x32_bf16 v[40:43], v[168:171], v[192:195], v[40:43]
    buffer_load_dwordx4 v[232:235], v7, s[44:47], s57 offen offset:3072 sc1
    v_mfma_f32_16x16x32_bf16 v[56:59], v[168:171], v[196:199], v[56:59]
    buffer_load_dwordx4 v[236:239], v7, s[44:47], s58 offen offset:3072 sc1
    v_mfma_f32_16x16x32_bf16 v[12:15], v[172:175], v[184:187], v[12:15]
    ds_read_b64_tr_b16 v[92:93], v253 offset:20480
    v_mfma_f32_16x16x32_bf16 v[28:31], v[172:175], v[188:191], v[28:31]
    ds_read_b64_tr_b16 v[94:95], v253 offset:20992
    v_mfma_f32_16x16x32_bf16 v[44:47], v[172:175], v[192:195], v[44:47]
    buffer_load_dwordx4 v[240:243], v7, s[44:47], s59 offen offset:3072 sc1
    v_mfma_f32_16x16x32_bf16 v[60:63], v[172:175], v[196:199], v[60:63]
    buffer_load_dwordx4 v[244:247], v7, s[44:47], s60 offen offset:3072 sc1
    s_add_u32 s57, s57, 4096
    s_add_u32 s58, s58, 4096
    s_add_u32 s59, s59, 4096
    s_add_u32 s60, s60, 4096
    v_mfma_f32_16x16x32_bf16 v[16:19], v[176:179], v[184:187], v[16:19]
    ds_read_b64_tr_b16 v[96:97], v254 offset:20480
    v_mfma_f32_16x16x32_bf16 v[32:35], v[176:179], v[188:191], v[32:35]
    ds_read_b64_tr_b16 v[98:99], v254 offset:20992
    v_mfma_f32_16x16x32_bf16 v[48:51], v[176:179], v[192:195], v[48:51]
    v_mfma_f32_16x16x32_bf16 v[64:67], v[176:179], v[196:199], v[64:67]
    v_mfma_f32_16x16x32_bf16 v[20:23], v[180:183], v[184:187], v[20:23]
    ds_read_b64_tr_b16 v[100:101], v255 offset:20480
    v_mfma_f32_16x16x32_bf16 v[36:39], v[180:183], v[188:191], v[36:39]
    ds_read_b64_tr_b16 v[102:103], v255 offset:20992
    v_mfma_f32_16x16x32_bf16 v[52:55], v[180:183], v[192:195], v[52:55]
    v_mfma_f32_16x16x32_bf16 v[68:71], v[180:183], v[196:199], v[68:71]
    s_waitcnt vmcnt(8)
    s_waitcnt lgkmcnt(6)
    v_mfma_f32_16x16x32_bf16 v[8:11], v[88:91], v[200:203], v[8:11]
    ds_read_b64_tr_b16 v[72:73], v252 offset:24576
    v_mfma_f32_16x16x32_bf16 v[24:27], v[88:91], v[204:207], v[24:27]
    ds_read_b64_tr_b16 v[74:75], v252 offset:25088
    v_mfma_f32_16x16x32_bf16 v[40:43], v[88:91], v[208:211], v[40:43]
    buffer_load_dwordx4 v[184:187], v7, s[44:47], s57 offen offset:0 sc1
    v_mfma_f32_16x16x32_bf16 v[56:59], v[88:91], v[212:215], v[56:59]
    buffer_load_dwordx4 v[188:191], v7, s[44:47], s58 offen offset:0 sc1
    s_waitcnt lgkmcnt(6)
    v_mfma_f32_16x16x32_bf16 v[12:15], v[92:95], v[200:203], v[12:15]
    ds_read_b64_tr_b16 v[76:77], v253 offset:24576
    v_mfma_f32_16x16x32_bf16 v[28:31], v[92:95], v[204:207], v[28:31]
    ds_read_b64_tr_b16 v[78:79], v253 offset:25088
    v_mfma_f32_16x16x32_bf16 v[44:47], v[92:95], v[208:211], v[44:47]
    buffer_load_dwordx4 v[192:195], v7, s[44:47], s59 offen offset:0 sc1
    v_mfma_f32_16x16x32_bf16 v[60:63], v[92:95], v[212:215], v[60:63]
    buffer_load_dwordx4 v[196:199], v7, s[44:47], s60 offen offset:0 sc1
    s_waitcnt lgkmcnt(6)
    v_mfma_f32_16x16x32_bf16 v[16:19], v[96:99], v[200:203], v[16:19]
    ds_read_b64_tr_b16 v[80:81], v254 offset:24576
    v_mfma_f32_16x16x32_bf16 v[32:35], v[96:99], v[204:207], v[32:35]
    ds_read_b64_tr_b16 v[82:83], v254 offset:25088
    v_mfma_f32_16x16x32_bf16 v[48:51], v[96:99], v[208:211], v[48:51]
    v_mfma_f32_16x16x32_bf16 v[64:67], v[96:99], v[212:215], v[64:67]
    s_waitcnt lgkmcnt(6)
    v_mfma_f32_16x16x32_bf16 v[20:23], v[100:103], v[200:203], v[20:23]
    ds_read_b64_tr_b16 v[84:85], v255 offset:24576
    v_mfma_f32_16x16x32_bf16 v[36:39], v[100:103], v[204:207], v[36:39]
    ds_read_b64_tr_b16 v[86:87], v255 offset:25088
    v_mfma_f32_16x16x32_bf16 v[52:55], v[100:103], v[208:211], v[52:55]
    v_mfma_f32_16x16x32_bf16 v[68:71], v[100:103], v[212:215], v[68:71]
    s_waitcnt vmcnt(8)
    s_waitcnt lgkmcnt(6)
    v_mfma_f32_16x16x32_bf16 v[8:11], v[72:75], v[216:219], v[8:11]
    ds_read_b64_tr_b16 v[88:89], v252 offset:28672
    v_mfma_f32_16x16x32_bf16 v[24:27], v[72:75], v[220:223], v[24:27]
    ds_read_b64_tr_b16 v[90:91], v252 offset:29184
    v_mfma_f32_16x16x32_bf16 v[40:43], v[72:75], v[224:227], v[40:43]
    buffer_load_dwordx4 v[200:203], v7, s[44:47], s57 offen offset:1024 sc1
    v_mfma_f32_16x16x32_bf16 v[56:59], v[72:75], v[228:231], v[56:59]
    buffer_load_dwordx4 v[204:207], v7, s[44:47], s58 offen offset:1024 sc1
    s_waitcnt lgkmcnt(6)
    v_mfma_f32_16x16x32_bf16 v[12:15], v[76:79], v[216:219], v[12:15]
    ds_read_b64_tr_b16 v[92:93], v253 offset:28672
    v_mfma_f32_16x16x32_bf16 v[28:31], v[76:79], v[220:223], v[28:31]
    ds_read_b64_tr_b16 v[94:95], v253 offset:29184
    v_mfma_f32_16x16x32_bf16 v[44:47], v[76:79], v[224:227], v[44:47]
    buffer_load_dwordx4 v[208:211], v7, s[44:47], s59 offen offset:1024 sc1
    v_mfma_f32_16x16x32_bf16 v[60:63], v[76:79], v[228:231], v[60:63]
    buffer_load_dwordx4 v[212:215], v7, s[44:47], s60 offen offset:1024 sc1
    s_waitcnt lgkmcnt(6)
    v_mfma_f32_16x16x32_bf16 v[16:19], v[80:83], v[216:219], v[16:19]
    ds_read_b64_tr_b16 v[96:97], v254 offset:28672
    v_mfma_f32_16x16x32_bf16 v[32:35], v[80:83], v[220:223], v[32:35]
    ds_read_b64_tr_b16 v[98:99], v254 offset:29184
    v_mfma_f32_16x16x32_bf16 v[48:51], v[80:83], v[224:227], v[48:51]
    v_mfma_f32_16x16x32_bf16 v[64:67], v[80:83], v[228:231], v[64:67]
    s_waitcnt lgkmcnt(6)
    v_mfma_f32_16x16x32_bf16 v[20:23], v[84:87], v[216:219], v[20:23]
    ds_read_b64_tr_b16 v[100:101], v255 offset:28672
    v_mfma_f32_16x16x32_bf16 v[36:39], v[84:87], v[220:223], v[36:39]
    ds_read_b64_tr_b16 v[102:103], v255 offset:29184
    v_mfma_f32_16x16x32_bf16 v[52:55], v[84:87], v[224:227], v[52:55]
    v_mfma_f32_16x16x32_bf16 v[68:71], v[84:87], v[228:231], v[68:71]
    s_waitcnt vmcnt(8)
    s_waitcnt lgkmcnt(6)
    v_mfma_f32_16x16x32_bf16 v[8:11], v[88:91], v[232:235], v[8:11]
    ds_read_b64_tr_b16 v[72:73], v252 offset:32768
    v_mfma_f32_16x16x32_bf16 v[24:27], v[88:91], v[236:239], v[24:27]
    ds_read_b64_tr_b16 v[74:75], v252 offset:33280
    v_mfma_f32_16x16x32_bf16 v[40:43], v[88:91], v[240:243], v[40:43]
    buffer_load_dwordx4 v[216:219], v7, s[44:47], s57 offen offset:2048 sc1
    v_mfma_f32_16x16x32_bf16 v[56:59], v[88:91], v[244:247], v[56:59]
    buffer_load_dwordx4 v[220:223], v7, s[44:47], s58 offen offset:2048 sc1
    s_waitcnt lgkmcnt(6)
    v_mfma_f32_16x16x32_bf16 v[12:15], v[92:95], v[232:235], v[12:15]
    ds_read_b64_tr_b16 v[76:77], v253 offset:32768
    v_mfma_f32_16x16x32_bf16 v[28:31], v[92:95], v[236:239], v[28:31]
    ds_read_b64_tr_b16 v[78:79], v253 offset:33280
    v_mfma_f32_16x16x32_bf16 v[44:47], v[92:95], v[240:243], v[44:47]
    buffer_load_dwordx4 v[224:227], v7, s[44:47], s59 offen offset:2048 sc1
    v_mfma_f32_16x16x32_bf16 v[60:63], v[92:95], v[244:247], v[60:63]
    buffer_load_dwordx4 v[228:231], v7, s[44:47], s60 offen offset:2048 sc1
    s_waitcnt lgkmcnt(6)
    v_mfma_f32_16x16x32_bf16 v[16:19], v[96:99], v[232:235], v[16:19]
    ds_read_b64_tr_b16 v[80:81], v254 offset:32768
    v_mfma_f32_16x16x32_bf16 v[32:35], v[96:99], v[236:239], v[32:35]
    ds_read_b64_tr_b16 v[82:83], v254 offset:33280
    v_mfma_f32_16x16x32_bf16 v[48:51], v[96:99], v[240:243], v[48:51]
    v_mfma_f32_16x16x32_bf16 v[64:67], v[96:99], v[244:247], v[64:67]
    s_waitcnt lgkmcnt(6)
    v_mfma_f32_16x16x32_bf16 v[20:23], v[100:103], v[232:235], v[20:23]
    ds_read_b64_tr_b16 v[84:85], v255 offset:32768
    v_mfma_f32_16x16x32_bf16 v[36:39], v[100:103], v[236:239], v[36:39]
    ds_read_b64_tr_b16 v[86:87], v255 offset:33280
    v_mfma_f32_16x16x32_bf16 v[52:55], v[100:103], v[240:243], v[52:55]
    v_mfma_f32_16x16x32_bf16 v[68:71], v[100:103], v[244:247], v[68:71]
    s_waitcnt vmcnt(8)
LW14:
    ds_read_b32 v251, v250 offset:104
    s_waitcnt lgkmcnt(0)
    v_readfirstlane_b32 s27, v251
    s_cmp_eq_u32 s24, 0
    s_cbranch_scc1 LW14_X
    s_sub_u32 s24, s24, 1
    s_cmp_lt_u32 s27, 4
    s_cbranch_scc1 LW14
LW14_X:
    s_waitcnt lgkmcnt(6)
    v_mfma_f32_16x16x32_bf16 v[8:11], v[72:75], v[184:187], v[8:11]
    ds_read_b64_tr_b16 v[88:89], v252 offset:0
    v_mfma_f32_16x16x32_bf16 v[24:27], v[72:75], v[188:191], v[24:27]
    ds_read_b64_tr_b16 v[90:91], v252 offset:512
    v_mfma_f32_16x16x32_bf16 v[40:43], v[72:75], v[192:195], v[40:43]
    buffer_load_dwordx4 v[232:235], v7, s[44:47], s57 offen offset:3072 sc1
    v_mfma_f32_16x16x32_bf16 v[56:59], v[72:75], v[196:199], v[56:59]
    buffer_load_dwordx4 v[236:239], v7, s[44:47], s58 offen offset:3072 sc1
    s_waitcnt lgkmcnt(6)
    v_mfma_f32_16x16x32_bf16 v[12:15], v[76:79], v[184:187], v[12:15]
    ds_read_b64_tr_b16 v[92:93], v253 offset:0
    v_mfma_f32_16x16x32_bf16 v[28:31], v[76:79], v[188:191], v[28:31]
    ds_read_b64_tr_b16 v[94:95], v253 offset:512
    v_mfma_f32_16x16x32_bf16 v[44:47], v[76:79], v[192:195], v[44:47]
    buffer_load_dwordx4 v[240:243], v7, s[44:47], s59 offen offset:3072 sc1
    v_mfma_f32_16x16x32_bf16 v[60:63], v[76:79], v[196:199], v[60:63]
    buffer_load_dwordx4 v[244:247], v7, s[44:47], s60 offen offset:3072 sc1
    s_add_u32 s57, s57, 4096
    s_add_u32 s58, s58, 4096
    s_add_u32 s59, s59, 4096
    s_add_u32 s60, s60, 4096
    s_waitcnt lgkmcnt(6)
    v_mfma_f32_16x16x32_bf16 v[16:19], v[80:83], v[184:187], v[16:19]
    ds_read_b64_tr_b16 v[96:97], v254 offset:0
    v_mfma_f32_16x16x32_bf16 v[32:35], v[80:83], v[188:191], v[32:35]
    ds_read_b64_tr_b16 v[98:99], v254 offset:512
    v_mfma_f32_16x16x32_bf16 v[48:51], v[80:83], v[192:195], v[48:51]
    v_mfma_f32_16x16x32_bf16 v[64:67], v[80:83], v[196:199], v[64:67]
    s_waitcnt lgkmcnt(6)
    v_mfma_f32_16x16x32_bf16 v[20:23], v[84:87], v[184:187], v[20:23]
    ds_read_b64_tr_b16 v[100:101], v255 offset:0
    v_mfma_f32_16x16x32_bf16 v[36:39], v[84:87], v[188:191], v[36:39]
    ds_read_b64_tr_b16 v[102:103], v255 offset:512
    v_mfma_f32_16x16x32_bf16 v[52:55], v[84:87], v[192:195], v[52:55]
    v_mfma_f32_16x16x32_bf16 v[68:71], v[84:87], v[196:199], v[68:71]
    s_add_u32 s52, s56, s21
    s_lshl_b32 s52, s52, 14
    s_lshl_b32 s53, s55, 11
    s_add_u32 s52, s52, s53
    s_lshl_b32 s53, s55, 8
    s_add_u32 s53, s53, 10240
    buffer_load_dwordx4 v[112:115], v248, s[40:43], s52 offen sc1
    buffer_load_dwordx4 v[116:119], v248, s[40:43], s52 offen offset:1024 sc1
    v_lshlrev_b32 v250, 4, v1
    s_mov_b32 exec_lo, 0xffff
    s_mov_b32 exec_hi, 0
    buffer_load_dwordx4 v[104:107], v250, s[36:39], s53 offen sc1
    s_add_u32 s53, s53, 12288
    buffer_load_dwordx4 v[108:111], v250, s[36:39], s53 offen sc1
    s_mov_b64 exec, -1
    s_waitcnt vmcnt(12)
    s_waitcnt lgkmcnt(6)
    v_mfma_f32_16x16x32_bf16 v[8:11], v[88:91], v[200:203], v[8:11]
    ds_read_b64_tr_b16 v[72:73], v252 offset:4096
    v_mfma_f32_16x16x32_bf16 v[24:27], v[88:91], v[204:207], v[24:27]
    ds_read_b64_tr_b16 v[74:75], v252 offset:4608
    v_mfma_f32_16x16x32_bf16 v[40:43], v[88:91], v[208:211], v[40:43]
    buffer_load_dwordx4 v[184:187], v7, s[44:47], s57 offen offset:0 sc1
    v_mfma_f32_16x16x32_bf16 v[56:59], v[88:91], v[212:215], v[56:59]
    buffer_load_dwordx4 v[188:191], v7, s[44:47], s58 offen offset:0 sc1
    s_waitcnt lgkmcnt(6)
    v_mfma_f32_16x16x32_bf16 v[12:15], v[92:95], v[200:203], v[12:15]
    ds_read_b64_tr_b16 v[76:77], v253 offset:4096
    v_mfma_f32_16x16x32_bf16 v[28:31], v[92:95], v[204:207], v[28:31]
    ds_read_b64_tr_b16 v[78:79], v253 offset:4608
    v_mfma_f32_16x16x32_bf16 v[44:47], v[92:95], v[208:211], v[44:47]
    buffer_load_dwordx4 v[192:195], v7, s[44:47], s59 offen offset:0 sc1
    v_mfma_f32_16x16x32_bf16 v[60:63], v[92:95], v[212:215], v[60:63]
    buffer_load_dwordx4 v[196:199], v7, s[44:47], s60 offen offset:0 sc1
    s_waitcnt lgkmcnt(6)
    v_mfma_f32_16x16x32_bf16 v[16:19], v[96:99], v[200:203], v[16:19]
    ds_read_b64_tr_b16 v[80:81], v254 offset:4096
    v_mfma_f32_16x16x32_bf16 v[32:35], v[96:99], v[204:207], v[32:35]
    ds_read_b64_tr_b16 v[82:83], v254 offset:4608
    v_mfma_f32_16x16x32_bf16 v[48:51], v[96:99], v[208:211], v[48:51]
    v_mfma_f32_16x16x32_bf16 v[64:67], v[96:99], v[212:215], v[64:67]
    s_waitcnt lgkmcnt(6)
    v_mfma_f32_16x16x32_bf16 v[20:23], v[100:103], v[200:203], v[20:23]
    ds_read_b64_tr_b16 v[84:85], v255 offset:4096
    v_mfma_f32_16x16x32_bf16 v[36:39], v[100:103], v[204:207], v[36:39]
    ds_read_b64_tr_b16 v[86:87], v255 offset:4608
    v_mfma_f32_16x16x32_bf16 v[52:55], v[100:103], v[208:211], v[52:55]
    v_mfma_f32_16x16x32_bf16 v[68:71], v[100:103], v[212:215], v[68:71]
    s_waitcnt vmcnt(12)
    s_waitcnt lgkmcnt(6)
    v_mfma_f32_16x16x32_bf16 v[8:11], v[72:75], v[216:219], v[8:11]
    ds_read_b64_tr_b16 v[88:89], v252 offset:8192
    v_mfma_f32_16x16x32_bf16 v[24:27], v[72:75], v[220:223], v[24:27]
    ds_read_b64_tr_b16 v[90:91], v252 offset:8704
    v_mfma_f32_16x16x32_bf16 v[40:43], v[72:75], v[224:227], v[40:43]
    buffer_load_dwordx4 v[200:203], v7, s[44:47], s57 offen offset:1024 sc1
    v_mfma_f32_16x16x32_bf16 v[56:59], v[72:75], v[228:231], v[56:59]
    buffer_load_dwordx4 v[204:207], v7, s[44:47], s58 offen offset:1024 sc1
    s_waitcnt lgkmcnt(6)
    v_mfma_f32_16x16x32_bf16 v[12:15], v[76:79], v[216:219], v[12:15]
    ds_read_b64_tr_b16 v[92:93], v253 offset:8192
    v_mfma_f32_16x16x32_bf16 v[28:31], v[76:79], v[220:223], v[28:31]
    ds_read_b64_tr_b16 v[94:95], v253 offset:8704
    v_mfma_f32_16x16x32_bf16 v[44:47], v[76:79], v[224:227], v[44:47]
    buffer_load_dwordx4 v[208:211], v7, s[44:47], s59 offen offset:1024 sc1
    v_mfma_f32_16x16x32_bf16 v[60:63], v[76:79], v[228:231], v[60:63]
    buffer_load_dwordx4 v[212:215], v7, s[44:47], s60 offen offset:1024 sc1
    s_waitcnt lgkmcnt(6)
    v_mfma_f32_16x16x32_bf16 v[16:19], v[80:83], v[216:219], v[16:19]
    ds_read_b64_tr_b16 v[96:97], v254 offset:8192
    v_mfma_f32_16x16x32_bf16 v[32:35], v[80:83], v[220:223], v[32:35]
    ds_read_b64_tr_b16 v[98:99], v254 offset:8704
    v_mfma_f32_16x16x32_bf16 v[48:51], v[80:83], v[224:227], v[48:51]
    v_mfma_f32_16x16x32_bf16 v[64:67], v[80:83], v[228:231], v[64:67]
    s_waitcnt lgkmcnt(6)
    v_mfma_f32_16x16x32_bf16 v[20:23], v[84:87], v[216:219], v[20:23]
    ds_read_b64_tr_b16 v[100:101], v255 offset:8192
    v_mfma_f32_16x16x32_bf16 v[36:39], v[84:87], v[220:223], v[36:39]
    ds_read_b64_tr_b16 v[102:103], v255 offset:8704
    v_mfma_f32_16x16x32_bf16 v[52:55], v[84:87], v[224:227], v[52:55]
    v_mfma_f32_16x16x32_bf16 v[68:71], v[84:87], v[228:231], v[68:71]
    s_waitcnt vmcnt(12)
    s_waitcnt lgkmcnt(6)
    v_mfma_f32_16x16x32_bf16 v[8:11], v[88:91], v[232:235], v[8:11]
    ds_read_b64_tr_b16 v[72:73], v252 offset:12288
    v_mfma_f32_16x16x32_bf16 v[24:27], v[88:91], v[236:239], v[24:27]
    ds_read_b64_tr_b16 v[74:75], v252 offset:12800
    v_mfma_f32_16x16x32_bf16 v[40:43], v[88:91], v[240:243], v[40:43]
    v_mfma_f32_16x16x32_bf16 v[56:59], v[88:91], v[244:247], v[56:59]
    s_waitcnt lgkmcnt(6)
    v_mfma_f32_16x16x32_bf16 v[12:15], v[92:95], v[232:235], v[12:15]
    ds_read_b64_tr_b16 v[76:77], v253 offset:12288
    v_mfma_f32_16x16x32_bf16 v[28:31], v[92:95], v[236:239], v[28:31]
    ds_read_b64_tr_b16 v[78:79], v253 offset:12800
    v_mfma_f32_16x16x32_bf16 v[44:47], v[92:95], v[240:243], v[44:47]
    v_mfma_f32_16x16x32_bf16 v[60:63], v[92:95], v[244:247], v[60:63]
    s_waitcnt lgkmcnt(6)
    v_mfma_f32_16x16x32_bf16 v[16:19], v[96:99], v[232:235], v[16:19]
    ds_read_b64_tr_b16 v[80:81], v254 offset:12288
    v_mfma_f32_16x16x32_bf16 v[32:35], v[96:99], v[236:239], v[32:35]
    ds_read_b64_tr_b16 v[82:83], v254 offset:12800
    v_mfma_f32_16x16x32_bf16 v[48:51], v[96:99], v[240:243], v[48:51]
    v_mfma_f32_16x16x32_bf16 v[64:67], v[96:99], v[244:247], v[64:67]
    s_waitcnt lgkmcnt(6)
    v_mfma_f32_16x16x32_bf16 v[20:23], v[100:103], v[232:235], v[20:23]
    ds_read_b64_tr_b16 v[84:85], v255 offset:12288
    v_mfma_f32_16x16x32_bf16 v[36:39], v[100:103], v[236:239], v[36:39]
    ds_read_b64_tr_b16 v[86:87], v255 offset:12800
    v_mfma_f32_16x16x32_bf16 v[52:55], v[100:103], v[240:243], v[52:55]
    v_mfma_f32_16x16x32_bf16 v[68:71], v[100:103], v[244:247], v[68:71]
    s_waitcnt vmcnt(4)
    s_waitcnt lgkmcnt(6)
    v_mfma_f32_16x16x32_bf16 v[8:11], v[72:75], v[184:187], v[8:11]
    ds_read_b64_tr_b16 v[88:89], v252 offset:16384
    v_mfma_f32_16x16x32_bf16 v[24:27], v[72:75], v[188:191], v[24:27]
    ds_read_b64_tr_b16 v[90:91], v252 offset:16896
    v_mfma_f32_16x16x32_bf16 v[40:43], v[72:75], v[192:195], v[40:43]
    v_mfma_f32_16x16x32_bf16 v[56:59], v[72:75], v[196:199], v[56:59]
    s_waitcnt lgkmcnt(6)
    v_mfma_f32_16x16x32_bf16 v[12:15], v[76:79], v[184:187], v[12:15]
    ds_read_b64_tr_b16 v[92:93], v253 offset:16384
    v_mfma_f32_16x16x32_bf16 v[28:31], v[76:79], v[188:191], v[28:31]
    ds_read_b64_tr_b16 v[94:95], v253 offset:16896
    v_mfma_f32_16x16x32_bf16 v[44:47], v[76:79], v[192:195], v[44:47]
    v_mfma_f32_16x16x32_bf16 v[60:63], v[76:79], v[196:199], v[60:63]
    s_waitcnt lgkmcnt(6)
    v_mfma_f32_16x16x32_bf16 v[16:19], v[80:83], v[184:187], v[16:19]
    ds_read_b64_tr_b16 v[96:97], v254 offset:16384
    v_mfma_f32_16x16x32_bf16 v[32:35], v[80:83], v[188:191], v[32:35]
    ds_read_b64_tr_b16 v[98:99], v254 offset:16896
    v_mfma_f32_16x16x32_bf16 v[48:51], v[80:83], v[192:195], v[48:51]
    v_mfma_f32_16x16x32_bf16 v[64:67], v[80:83], v[196:199], v[64:67]
    s_waitcnt lgkmcnt(6)
    v_mfma_f32_16x16x32_bf16 v[20:23], v[84:87], v[184:187], v[20:23]
    ds_read_b64_tr_b16 v[100:101], v255 offset:16384
    v_mfma_f32_16x16x32_bf16 v[36:39], v[84:87], v[188:191], v[36:39]
    ds_read_b64_tr_b16 v[102:103], v255 offset:16896
    v_mfma_f32_16x16x32_bf16 v[52:55], v[84:87], v[192:195], v[52:55]
    v_mfma_f32_16x16x32_bf16 v[68:71], v[84:87], v[196:199], v[68:71]
    s_waitcnt vmcnt(0)
    s_waitcnt lgkmcnt(6)
    v_mfma_f32_16x16x32_bf16 v[8:11], v[88:91], v[200:203], v[8:11]
    v_mfma_f32_16x16x32_bf16 v[24:27], v[88:91], v[204:207], v[24:27]
    v_mfma_f32_16x16x32_bf16 v[40:43], v[88:91], v[208:211], v[40:43]
    v_mfma_f32_16x16x32_bf16 v[56:59], v[88:91], v[212:215], v[56:59]
    s_waitcnt lgkmcnt(4)
    v_mfma_f32_16x16x32_bf16 v[12:15], v[92:95], v[200:203], v[12:15]
    v_mfma_f32_16x16x32_bf16 v[28:31], v[92:95], v[204:207], v[28:31]
    v_mfma_f32_16x16x32_bf16 v[44:47], v[92:95], v[208:211], v[44:47]
    v_mfma_f32_16x16x32_bf16 v[60:63], v[92:95], v[212:215], v[60:63]
    s_waitcnt lgkmcnt(2)
    v_mfma_f32_16x16x32_bf16 v[16:19], v[96:99], v[200:203], v[16:19]
    v_mfma_f32_16x16x32_bf16 v[32:35], v[96:99], v[204:207], v[32:35]
    v_mfma_f32_16x16x32_bf16 v[48:51], v[96:99], v[208:211], v[48:51]
    v_mfma_f32_16x16x32_bf16 v[64:67], v[96:99], v[212:215], v[64:67]
    s_waitcnt lgkmcnt(0)
    v_mfma_f32_16x16x32_bf16 v[20:23], v[100:103], v[200:203], v[20:23]
    v_mfma_f32_16x16x32_bf16 v[36:39], v[100:103], v[204:207], v[36:39]
    v_mfma_f32_16x16x32_bf16 v[52:55], v[100:103], v[208:211], v[52:55]
    v_mfma_f32_16x16x32_bf16 v[68:71], v[100:103], v[212:215], v[68:71]
    v_lshlrev_b32 v250, 4, v1
    v_add_u32 v251, s62, v250
    ds_write_b128 v251, v[24:27] offset:0
    ds_write_b128 v251, v[28:31] offset:1024
    ds_write_b128 v251, v[32:35] offset:2048
    s_nop 0
    ds_write_b128 v251, v[36:39] offset:3072
    ds_write_b128 v251, v[40:43] offset:4096
    ds_write_b128 v251, v[44:47] offset:5120
    ds_write_b128 v251, v[48:51] offset:6144
    ds_write_b128 v251, v[52:55] offset:7168
    ds_write_b128 v251, v[56:59] offset:8192
    ds_write_b128 v251, v[60:63] offset:9216
    ds_write_b128 v251, v[64:67] offset:10240
    ds_write_b128 v251, v[68:71] offset:11264
    s_add_u32 s52, s56, s21
    s_lshl_b32 s52, s52, 4
    v_add_u32 v128, s52, v3
    v_lshrrev_b32 v129, 6, v128
    v_bfe_u32 v130, v128, 1, 5
    v_and_b32 v131, 1, v128
    v_lshlrev_b32 v132, 6, v130
    v_add_u32 v133, v129, v132
    v_cmp_eq_u32 vcc, 0, v129
    v_subrev_u32 v134, 992, v132
    v_cmp_lt_u32 s[52:53], 15, v130
    s_nop 1
    v_cndmask_b32 v134, v132, v134, s[52:53]
    v_cndmask_b32 v133, v133, v134, vcc
    v_sub_u32 v134, 2048, v133
    v_lshrrev_b32 v135, 1, v128
    v_cmp_eq_u32 vcc, 0, v135
    v_mov_b32 v135, 1024
    s_nop 0
    v_cndmask_b32 v134, v134, v135, vcc
    v_cmp_eq_u32 vcc, 1, v131
    s_nop 1
    v_cndmask_b32 v133, v133, v134, vcc
    v_lshlrev_b32 v133, 10, v133
    v_add_u32 v133, v133, v249
    s_mov_b32 s28, s12
    s_mov_b32 s29, s13
    s_mov_b32 s30, 2097152
    s_mov_b32 s31, 0x20000
    s_waitcnt vmcnt(0)
    v_add_f32 v104, v104, v108
    v_add_f32 v105, v105, v109
    v_add_f32 v106, v106, v110
    v_add_f32 v107, v107, v111
    v_cvt_pk_bf16_f32 v108, v104, v105
    v_cvt_pk_bf16_f32 v109, v106, v107
    s_lshl_b32 s52, s21, 7
    s_add_u32 s52, s52, 163008
    v_lshlrev_b32 v110, 3, v1
    v_add_u32 v110, s52, v110
    s_mov_b32 exec_lo, 0xffff
    s_mov_b32 exec_hi, 0
    ds_write_b64 v110, v[108:109]
    s_mov_b64 exec, -1
    v_add_u32 v111, s52, v249
    ds_read_b128 v[120:123], v111
    ds_read_b128 v[124:127], v111 offset:64
    s_waitcnt lgkmcnt(0)
    v_lshlrev_b32 v72, 16, v112
    v_and_b32 v73, 0xffff0000, v112
    v_lshlrev_b32 v74, 16, v113
    v_and_b32 v75, 0xffff0000, v113
    v_lshlrev_b32 v76, 16, v114
    v_and_b32 v77, 0xffff0000, v114
    v_lshlrev_b32 v78, 16, v115
    v_and_b32 v79, 0xffff0000, v115
    v_lshlrev_b32 v88, 16, v120
    v_and_b32 v89, 0xffff0000, v120
    v_lshlrev_b32 v90, 16, v121
    v_and_b32 v91, 0xffff0000, v121
    v_lshlrev_b32 v92, 16, v122
    v_and_b32 v93, 0xffff0000, v122
    v_lshlrev_b32 v94, 16, v123
    v_and_b32 v95, 0xffff0000, v123
    v_lshlrev_b32 v80, 16, v116
    v_and_b32 v81, 0xffff0000, v116
    v_lshlrev_b32 v82, 16, v117
    v_and_b32 v83, 0xffff0000, v117
    v_lshlrev_b32 v84, 16, v118
    v_and_b32 v85, 0xffff0000, v118
    v_lshlrev_b32 v86, 16, v119
    v_and_b32 v87, 0xffff0000, v119
    v_lshlrev_b32 v96, 16, v124
    v_and_b32 v97, 0xffff0000, v124
    v_lshlrev_b32 v98, 16, v125
    v_and_b32 v99, 0xffff0000, v125
    v_lshlrev_b32 v100, 16, v126
    v_and_b32 v101, 0xffff0000, v126
    v_lshlrev_b32 v102, 16, v127
    v_and_b32 v103, 0xffff0000, v127
    s_sub_u32 s52, s21, 1
    s_and_b32 s52, s52, 3
    s_mul_i32 s52, s52, 36864
    v_add_u32 v137, s52, v250
    s_sub_u32 s52, s21, 2
    s_and_b32 s52, s52, 3
    s_mul_i32 s52, s52, 36864
    v_add_u32 v138, s52, v250
    s_sub_u32 s52, s21, 3
    s_and_b32 s52, s52, 3
    s_mul_i32 s52, s52, 36864
    v_add_u32 v139, s52, v250
    s_lshl_b32 s52, s55, 7
    s_waitcnt lgkmcnt(0)
    s_barrier
    ds_read_b128 v[140:143], v137 offset:0
    ds_read_b128 v[156:159], v138 offset:4096
    ds_read_b128 v[172:175], v139 offset:8192
    ds_read_b128 v[144:147], v137 offset:1024
    ds_read_b128 v[160:163], v138 offset:5120
    ds_read_b128 v[176:179], v139 offset:9216
    ds_read_b128 v[148:151], v137 offset:2048
    ds_read_b128 v[164:167], v138 offset:6144
    ds_read_b128 v[180:183], v139 offset:10240
    ds_read_b128 v[152:155], v137 offset:3072
    ds_read_b128 v[168:171], v138 offset:7168
    ds_read_b128 v[184:187], v139 offset:11264
    s_waitcnt lgkmcnt(9)
    v_add_f32 v8, v8, v140
    v_add_f32 v156, v156, v172
    v_add_f32 v9, v9, v141
    v_add_f32 v157, v157, v173
    v_add_f32 v10, v10, v142
    v_add_f32 v158, v158, v174
    v_add_f32 v11, v11, v143
    v_add_f32 v159, v159, v175
    v_add_f32 v8, v8, v156
    v_add_f32 v9, v9, v157
    v_add_f32 v10, v10, v158
    v_add_f32 v11, v11, v159
    s_waitcnt lgkmcnt(6)
    v_add_f32 v12, v12, v144
    v_add_f32 v160, v160, v176
    v_add_f32 v13, v13, v145
    v_add_f32 v161, v161, v177
    v_add_f32 v14, v14, v146
    v_add_f32 v162, v162, v178
    v_add_f32 v15, v15, v147
    v_add_f32 v163, v163, v179
    v_add_f32 v12, v12, v160
    v_add_f32 v13, v13, v161
    v_add_f32 v14, v14, v162
    v_add_f32 v15, v15, v163
    v_permlane16_swap_b32 v8, v12
    v_permlane16_swap_b32 v9, v13
    v_permlane16_swap_b32 v10, v14
    v_permlane16_swap_b32 v11, v15
    v_fma_f32 v72, v88, v8, v72
    v_fma_f32 v73, v89, v9, v73
    v_fma_f32 v74, v90, v10, v74
    v_fma_f32 v75, v91, v11, v75
    v_fma_f32 v76, v92, v12, v76
    v_fma_f32 v77, v93, v13, v77
    v_fma_f32 v78, v94, v14, v78
    v_fma_f32 v79, v95, v15, v79
    v_cvt_pk_bf16_f32 v56, v72, v73
    v_cvt_pk_bf16_f32 v57, v74, v75
    v_cvt_pk_bf16_f32 v58, v76, v77
    v_cvt_pk_bf16_f32 v59, v78, v79
    buffer_store_dwordx4 v[56:59], v133, s[28:31], s52 offen offset:0 sc1
    s_waitcnt lgkmcnt(3)
    v_add_f32 v16, v16, v148
    v_add_f32 v164, v164, v180
    v_add_f32 v17, v17, v149
    v_add_f32 v165, v165, v181
    v_add_f32 v18, v18, v150
    v_add_f32 v166, v166, v182
    v_add_f32 v19, v19, v151
    v_add_f32 v167, v167, v183
    v_add_f32 v16, v16, v164
    v_add_f32 v17, v17, v165
    v_add_f32 v18, v18, v166
    v_add_f32 v19, v19, v167
    s_waitcnt lgkmcnt(0)
    v_add_f32 v20, v20, v152
    v_add_f32 v168, v168, v184
    v_add_f32 v21, v21, v153
    v_add_f32 v169, v169, v185
    v_add_f32 v22, v22, v154
    v_add_f32 v170, v170, v186
    v_add_f32 v23, v23, v155
    v_add_f32 v171, v171, v187
    v_add_f32 v20, v20, v168
    v_add_f32 v21, v21, v169
    v_add_f32 v22, v22, v170
    v_add_f32 v23, v23, v171
    v_permlane16_swap_b32 v16, v20
    v_permlane16_swap_b32 v17, v21
    v_permlane16_swap_b32 v18, v22
    v_permlane16_swap_b32 v19, v23
    v_fma_f32 v80, v96, v16, v80
    v_fma_f32 v81, v97, v17, v81
    v_fma_f32 v82, v98, v18, v82
    v_fma_f32 v83, v99, v19, v83
    v_fma_f32 v84, v100, v20, v84
    v_fma_f32 v85, v101, v21, v85
    v_fma_f32 v86, v102, v22, v86
    v_fma_f32 v87, v103, v23, v87
    v_cvt_pk_bf16_f32 v60, v80, v81
    v_cvt_pk_bf16_f32 v61, v82, v83
    v_cvt_pk_bf16_f32 v62, v84, v85
    v_cvt_pk_bf16_f32 v63, v86, v87
    buffer_store_dwordx4 v[60:63], v133, s[28:31], s52 offen offset:64 sc1
    s_endpgm
L_HELPER:
    s_waitcnt lgkmcnt(0)
    v_lshlrev_b32 v7, 4, v1
    v_mov_b32 v60, 0
    v_mov_b32 v61, 0
    s_cmp_lg_u32 s2, 0
    s_cbranch_scc1 H_NOINIT
    s_mov_b32 s40, s6
    s_mov_b32 s41, s7
    s_mov_b32 s42, 27648
    s_mov_b32 s43, 0x20000
    v_mov_b32 v12, 0
    v_mov_b32 v13, 0
    v_mov_b32 v14, 0
    v_mov_b32 v15, 0
    s_lshl_b32 s52, s21, 11
    s_add_u32 s52, s52, 0x4C00
    buffer_store_dwordx4 v[12:15], v7, s[40:43], s52 offen sc1
    buffer_store_dwordx4 v[12:15], v7, s[40:43], s52 offen offset:1024 sc1
H_NOINIT:
    s_and_b32 s55, s23, 1
    s_lshr_b32 s52, s23, 2
    s_lshl_b32 s52, s52, 1
    s_add_u32 s55, s55, s52
    s_lshr_b32 s52, s21, 1
    s_lshl_b32 s52, s52, 3
    v_lshl_add_u32 v4, v2, 1, s52
    v_xor_b32 v4, v4, v3
    s_and_b32 s52, s55, 1
    s_lshl_b32 s52, s52, 1
    v_add_u32 v6, s52, v4
    v_subrev_u32 v12, 14, v6
    v_cmp_le_u32 vcc, 14, v6
    s_nop 1
    v_cndmask_b32 v6, v6, v12, vcc
    v_mul_u32_u24 v5, 3584, v2
    v_lshl_add_u32 v5, v6, 4, v5
    s_mul_i32 s52, s55, 224
    v_add_u32 v5, s52, v5
    v_cmp_gt_u32 vcc, 14, v4
    v_mov_b32 v6, 0x40000000
    s_nop 0
    v_cndmask_b32 v5, v6, v5, vcc
    s_mul_i32 s56, s21, 14336
    s_lshl_b32 s57, s21, 10
    s_mul_i32 s58, s23, 57344
    s_mul_i32 s52, s21, 14336
    s_add_u32 s58, s58, s52
    s_mov_b32 s28, s8
    s_mov_b32 s29, s9
    s_mov_b32 s30, 1835008
    s_mov_b32 s31, 0x20000
    s_mov_b32 s32, s10
    s_mov_b32 s33, s11
    s_mov_b32 s34, 1835008
    s_mov_b32 s35, 0x20000
    s_cmp_ge_u32 s23, 28
    s_cbranch_scc1 MOD_XH
    s_cmp_lt_u32 s23, 16
    s_cbranch_scc1 MOD_XH
    s_sub_u32 s52, s23, 16
    s_lshl_b32 s52, s52, 3
    s_add_u32 s52, s52, s22
    s_cmp_ge_u32 s52, 48
    s_cselect_b32 s63, 1, 0
    s_mul_i32 s53, s63, 48
    s_sub_u32 s60, s52, s53
    s_mov_b32 s40, s16
    s_mov_b32 s41, s17
    s_mov_b32 s42, 1024
    s_mov_b32 s43, 0x20000
    s_mov_b32 s44, s18
    s_mov_b32 s45, s19
    s_mov_b32 s46, 3145728
    s_mov_b32 s47, 0x20000
    v_lshrrev_b32 v62, 3, v1
    v_and_b32 v63, 7, v1
    s_lshl_b32 s54, s63, 8
    s_lshl_b32 s59, s20, 5
    s_add_u32 s54, s54, s59
    v_add_u32 v10, s54, v62
    v_mul_u32_u24 v11, 6144, v10
    v_lshl_add_u32 v11, v63, 4, v11
    s_lshl_b32 s59, s60, 7
    v_lshlrev_b32 v10, 1, v10
    buffer_load_dwordx4 v[16:19], v11, s[44:47], s59 offen
    s_add_u32 s59, s59, 49152
    buffer_load_dwordx4 v[20:23], v11, s[44:47], s59 offen
    s_add_u32 s59, s59, 49152
    buffer_load_dwordx4 v[24:27], v11, s[44:47], s59 offen
    s_add_u32 s59, s59, 49152
    buffer_load_dwordx4 v[28:31], v11, s[44:47], s59 offen
    buffer_load_ushort v32, v10, s[40:43], 0 offen offset:0
    buffer_load_ushort v33, v10, s[40:43], 0 offen offset:16
    buffer_load_ushort v34, v10, s[40:43], 0 offen offset:32
    buffer_load_ushort v35, v10, s[40:43], 0 offen offset:48
    s_waitcnt vmcnt(0)
    v_lshlrev_b32 v32, 16, v32
    v_lshlrev_b32 v33, 16, v33
    v_lshlrev_b32 v34, 16, v34
    v_lshlrev_b32 v35, 16, v35
    v_mul_f32 v48, 0xbfb8aa3b, v32
    v_mul_f32 v49, 0xbfb8aa3b, v33
    v_mul_f32 v50, 0xbfb8aa3b, v34
    v_mul_f32 v51, 0xbfb8aa3b, v35
    v_exp_f32 v48, v48
    v_exp_f32 v49, v49
    v_exp_f32 v50, v50
    v_exp_f32 v51, v51
    v_add_f32 v48, 1.0, v48
    v_add_f32 v49, 1.0, v49
    v_add_f32 v50, 1.0, v50
    v_add_f32 v51, 1.0, v51
    v_rcp_f32 v48, v48
    v_rcp_f32 v49, v49
    v_rcp_f32 v50, v50
    v_rcp_f32 v51, v51
    v_mul_f32 v48, v32, v48
    v_mul_f32 v49, v33, v49
    v_mul_f32 v50, v34, v50
    v_mul_f32 v51, v35, v51
    v_cvt_pk_bf16_f32 v32, v48, 0
    v_cvt_pk_bf16_f32 v33, v49, 0
    v_cvt_pk_bf16_f32 v34, v50, 0
    v_cvt_pk_bf16_f32 v35, v51, 0
    v_lshlrev_b32 v36, 16, v32
    v_lshlrev_b32 v37, 16, v33
    v_lshlrev_b32 v38, 16, v34
    v_lshlrev_b32 v39, 16, v35
    v_dot2_f32_bf16 v40, v16, v32, 0
    v_dot2_f32_bf16 v41, v16, v36, 0
    v_dot2_f32_bf16 v42, v17, v32, 0
    v_dot2_f32_bf16 v43, v17, v36, 0
    v_dot2_f32_bf16 v44, v18, v32, 0
    v_dot2_f32_bf16 v45, v18, v36, 0
    v_dot2_f32_bf16 v46, v19, v32, 0
    v_dot2_f32_bf16 v47, v19, v36, 0
    v_dot2_f32_bf16 v40, v20, v33, v40
    v_dot2_f32_bf16 v41, v20, v37, v41
    v_dot2_f32_bf16 v42, v21, v33, v42
    v_dot2_f32_bf16 v43, v21, v37, v43
    v_dot2_f32_bf16 v44, v22, v33, v44
    v_dot2_f32_bf16 v45, v22, v37, v45
    v_dot2_f32_bf16 v46, v23, v33, v46
    v_dot2_f32_bf16 v47, v23, v37, v47
    v_dot2_f32_bf16 v40, v24, v34, v40
    v_dot2_f32_bf16 v41, v24, v38, v41
    v_dot2_f32_bf16 v42, v25, v34, v42
    v_dot2_f32_bf16 v43, v25, v38, v43
    v_dot2_f32_bf16 v44, v26, v34, v44
    v_dot2_f32_bf16 v45, v26, v38, v45
    v_dot2_f32_bf16 v46, v27, v34, v46
    v_dot2_f32_bf16 v47, v27, v38, v47
    v_dot2_f32_bf16 v40, v28, v35, v40
    v_dot2_f32_bf16 v41, v28, v39, v41
    v_dot2_f32_bf16 v42, v29, v35, v42
    v_dot2_f32_bf16 v43, v29, v39, v43
    v_dot2_f32_bf16 v44, v30, v35, v44
    v_dot2_f32_bf16 v45, v30, v39, v45
    v_dot2_f32_bf16 v46, v31, v35, v46
    v_dot2_f32_bf16 v47, v31, v39, v47
    v_add_f32_dpp v40, v40, v40 row_ror:8 row_mask:0xf bank_mask:0xf
    v_add_f32_dpp v41, v41, v41 row_ror:8 row_mask:0xf bank_mask:0xf
    v_add_f32_dpp v42, v42, v42 row_ror:8 row_mask:0xf bank_mask:0xf
    v_add_f32_dpp v43, v43, v43 row_ror:8 row_mask:0xf bank_mask:0xf
    v_add_f32_dpp v44, v44, v44 row_ror:8 row_mask:0xf bank_mask:0xf
    v_add_f32_dpp v45, v45, v45 row_ror:8 row_mask:0xf bank_mask:0xf
    v_add_f32_dpp v46, v46, v46 row_ror:8 row_mask:0xf bank_mask:0xf
    v_add_f32_dpp v47, v47, v47 row_ror:8 row_mask:0xf bank_mask:0xf
    v_mov_b32 v48, v40
    v_mov_b32 v49, v41
    v_mov_b32 v50, v42
    v_mov_b32 v51, v43
    v_mov_b32 v52, v44
    v_mov_b32 v53, v45
    v_mov_b32 v54, v46
    v_mov_b32 v55, v47
    v_permlane16_swap_b32 v40, v48
    v_permlane16_swap_b32 v41, v49
    v_permlane16_swap_b32 v42, v50
    v_permlane16_swap_b32 v43, v51
    v_permlane16_swap_b32 v44, v52
    v_permlane16_swap_b32 v45, v53
    v_permlane16_swap_b32 v46, v54
    v_permlane16_swap_b32 v47, v55
    v_add_f32 v40, v40, v48
    v_add_f32 v41, v41, v49
    v_add_f32 v42, v42, v50
    v_add_f32 v43, v43, v51
    v_add_f32 v44, v44, v52
    v_add_f32 v45, v45, v53
    v_add_f32 v46, v46, v54
    v_add_f32 v47, v47, v55
    v_mov_b32 v48, v40
    v_mov_b32 v49, v41
    v_mov_b32 v50, v42
    v_mov_b32 v51, v43
    v_mov_b32 v52, v44
    v_mov_b32 v53, v45
    v_mov_b32 v54, v46
    v_mov_b32 v55, v47
    v_permlane32_swap_b32 v40, v48
    v_permlane32_swap_b32 v41, v49
    v_permlane32_swap_b32 v42, v50
    v_permlane32_swap_b32 v43, v51
    v_permlane32_swap_b32 v44, v52
    v_permlane32_swap_b32 v45, v53
    v_permlane32_swap_b32 v46, v54
    v_permlane32_swap_b32 v47, v55
    v_add_f32 v40, v40, v48
    v_add_f32 v41, v41, v49
    v_add_f32 v42, v42, v50
    v_add_f32 v43, v43, v51
    v_add_f32 v44, v44, v52
    v_add_f32 v45, v45, v53
    v_add_f32 v46, v46, v54
    v_add_f32 v47, v47, v55
    v_mov_b32 v60, v40
    v_cmp_eq_u32 vcc, 1, v62
    s_nop 1
    v_cndmask_b32 v60, v60, v41, vcc
    v_cmp_eq_u32 vcc, 2, v62
    s_nop 1
    v_cndmask_b32 v60, v60, v42, vcc
    v_cmp_eq_u32 vcc, 3, v62
    s_nop 1
    v_cndmask_b32 v60, v60, v43, vcc
    v_cmp_eq_u32 vcc, 4, v62
    s_nop 1
    v_cndmask_b32 v60, v60, v44, vcc
    v_cmp_eq_u32 vcc, 5, v62
    s_nop 1
    v_cndmask_b32 v60, v60, v45, vcc
    v_cmp_eq_u32 vcc, 6, v62
    s_nop 1
    v_cndmask_b32 v60, v60, v46, vcc
    v_cmp_eq_u32 vcc, 7, v62
    s_nop 1
    v_cndmask_b32 v60, v60, v47, vcc
    v_lshlrev_b32 v61, 3, v63
    v_add_u32 v61, v61, v62
    v_lshlrev_b32 v61, 2, v61
    s_lshl_b32 s52, s20, 8
    s_add_u32 s52, s52, 158784
    v_add_u32 v61, s52, v61
    ds_write_b32 v61, v60
    v_mov_b32 v12, 162880
    v_mov_b32 v13, 1
    s_mov_b64 exec, 1
    ds_add_rtn_u32 v14, v12, v13 offset:88
    s_mov_b64 exec, -1
    s_waitcnt lgkmcnt(0)
    v_readfirstlane_b32 s27, v14
    s_cmp_lg_u32 s27, 7
    s_cbranch_scc1 MOD_XH
    v_lshlrev_b32 v61, 2, v1
    v_add_u32 v12, 158784, v61
    ds_read_b32 v16, v12 offset:0
    ds_read_b32 v17, v12 offset:256
    ds_read_b32 v18, v12 offset:512
    ds_read_b32 v19, v12 offset:768
    ds_read_b32 v20, v12 offset:1024
    ds_read_b32 v21, v12 offset:1280
    ds_read_b32 v22, v12 offset:1536
    ds_read_b32 v23, v12 offset:1792
    s_lshl_b32 s52, s60, 8
    s_mul_i32 s53, s63, 12288
    s_add_u32 s52, s52, s53
    s_add_u32 s40, s6, 14680064
    s_addc_u32 s41, s7, 0
    s_mov_b32 s42, 24576
    s_mov_b32 s43, 0x20000
    s_waitcnt lgkmcnt(0)
    v_add_f32 v16, v16, v17
    v_add_f32 v18, v18, v19
    v_add_f32 v20, v20, v21
    v_add_f32 v22, v22, v23
    v_add_f32 v16, v16, v18
    v_add_f32 v20, v20, v22
    v_add_f32 v16, v16, v20
    buffer_store_dword v16, v61, s[40:43], s52 offen sc1
MOD_XH:
    s_cmp_lg_u32 s21, 0
    s_cbranch_scc1 H_NOGX
    s_mov_b32 s44, s6
    s_mov_b32 s45, s7
    s_mov_b32 s46, 65536
    s_mov_b32 s47, 0x20000
    s_bfe_u32 s52, s23, 0x10001
    s_lshl_b32 s53, s22, 1
    s_add_u32 s52, s52, s53
    s_lshl_b32 s52, s52, 7
    s_add_u32 s52, s52, 32768
    s_lshl_b32 s53, s55, 2
    s_add_u32 s52, s52, s53
    s_getreg_b32 s53, hwreg(HW_REG_XCC_ID)
    s_and_b32 s53, s53, 15
    v_mov_b32 v12, s53
    v_mov_b32 v13, 0
    s_mov_b64 exec, 1
    buffer_store_dword v12, v13, s[44:47], s52 offen sc1
    s_mov_b64 exec, -1
H_NOGX:
    s_waitcnt vmcnt(0)
    s_mov_b32 s40, s14
    s_mov_b32 s41, s15
    s_mov_b32 s42, 256
    s_mov_b32 s43, 0x20000
    v_mov_b32 v12, 162880
    v_mov_b32 v13, 1
    s_mov_b64 exec, 1
    ds_add_rtn_u32 v14, v12, v13 offset:8
    s_waitcnt lgkmcnt(0)
    v_readfirstlane_b32 s27, v14
    s_cmp_lg_u32 s27, 7
    s_cbranch_scc1 HS1_A
    s_lshl_b32 s52, s22, 5
    v_mov_b32 v14, s52
    buffer_atomic_add v13, v14, s[40:43], 0 offen
HS1_A:
    s_mov_b64 exec, -1
    s_cmp_lt_u32 s23, 16
    s_cbranch_scc1 H_NOWARM
    s_sub_u32 s61, s23, 16
    s_lshl_b32 s61, s61, 3
    s_add_u32 s61, s61, s22
    s_mul_i32 s61, s61, 14336
    s_lshl_b32 s62, s21, 12
    s_add_u32 s61, s61, s62
    buffer_load_dwordx4 v[64:67], v7, s[28:31], s61 offen offset:0
    buffer_load_dwordx4 v[64:67], v7, s[28:31], s61 offen offset:1024
    buffer_load_dwordx4 v[64:67], v7, s[28:31], s61 offen offset:2048
    buffer_load_dwordx4 v[64:67], v7, s[28:31], s61 offen offset:3072
H_NOWARM:
    s_mov_b32 m0, s57
    s_nop 0
    buffer_load_dwordx4 v5, s[28:31], s56 offen lds
    s_add_u32 s56, s56, 57344
    s_add_u32 s57, s57, 4096
    s_mov_b32 m0, s57
    s_nop 0
    buffer_load_dwordx4 v5, s[28:31], s56 offen lds
    s_add_u32 s56, s56, 57344
    s_add_u32 s57, s57, 4096
    s_mov_b32 m0, s57
    s_nop 0
    buffer_load_dwordx4 v5, s[28:31], s56 offen lds
    s_add_u32 s56, s56, 57344
    s_add_u32 s57, s57, 4096
    s_mov_b32 m0, s57
    s_nop 0
    buffer_load_dwordx4 v5, s[28:31], s56 offen lds
    s_add_u32 s56, s56, 57344
    s_add_u32 s57, s57, 4096
    s_mov_b32 m0, s57
    s_nop 0
    buffer_load_dwordx4 v5, s[28:31], s56 offen lds
    s_add_u32 s56, s56, 57344
    s_add_u32 s57, s57, 4096
    s_mov_b32 m0, s57
    s_nop 0
    buffer_load_dwordx4 v5, s[28:31], s56 offen lds
    s_add_u32 s56, s56, 57344
    s_add_u32 s57, s57, 4096
    s_mov_b32 m0, s57
    s_nop 0
    buffer_load_dwordx4 v5, s[28:31], s56 offen lds
    s_add_u32 s56, s56, 57344
    s_add_u32 s57, s57, 4096
    s_waitcnt vmcnt(7)
    s_mov_b32 m0, s57
    s_nop 0
    buffer_load_dwordx4 v5, s[28:31], s56 offen lds
    s_add_u32 s56, s56, 57344
    s_add_u32 s57, s57, 4096
    s_waitcnt vmcnt(7)
    s_mov_b32 m0, s57
    s_nop 0
    buffer_load_dwordx4 v5, s[28:31], s56 offen lds
    s_add_u32 s56, s56, 57344
    s_add_u32 s57, s57, 4096
    s_waitcnt vmcnt(7)
    s_mov_b32 m0, s57
    s_nop 0
    buffer_load_dwordx4 v5, s[28:31], s56 offen lds
    s_add_u32 s56, s56, 57344
    s_add_u32 s57, s57, 4096
    s_waitcnt vmcnt(7)
    s_mov_b32 m0, s57
    s_nop 0
    buffer_load_dwordx4 v5, s[28:31], s56 offen lds
    s_add_u32 s56, s56, 57344
    s_add_u32 s57, s57, 4096
    s_waitcnt vmcnt(7)
    s_mov_b32 m0, s57
    s_nop 0
    buffer_load_dwordx4 v5, s[28:31], s56 offen lds
    s_add_u32 s56, s56, 57344
    s_add_u32 s57, s57, 4096
    s_waitcnt vmcnt(7)
    s_mov_b32 m0, s57
    s_nop 0
    buffer_load_dwordx4 v5, s[28:31], s56 offen lds
    s_add_u32 s56, s56, 57344
    s_add_u32 s57, s57, 4096
    s_waitcnt vmcnt(7)
    s_mov_b32 m0, s57
    s_nop 0
    buffer_load_dwordx4 v5, s[28:31], s56 offen lds
    s_add_u32 s56, s56, 57344
    s_add_u32 s57, s57, 4096
    s_waitcnt vmcnt(7)
    s_mov_b32 m0, s57
    s_nop 0
    buffer_load_dwordx4 v5, s[28:31], s56 offen lds
    s_add_u32 s56, s56, 57344
    s_add_u32 s57, s57, 4096
    s_waitcnt vmcnt(7)
    s_mov_b32 m0, s57
    s_nop 0
    buffer_load_dwordx4 v5, s[28:31], s56 offen lds
    s_add_u32 s56, s56, 57344
    s_add_u32 s57, s57, 4096
    s_waitcnt vmcnt(7)
    s_mov_b32 m0, s57
    s_nop 0
    buffer_load_dwordx4 v5, s[28:31], s56 offen lds
    s_add_u32 s56, s56, 57344
    s_add_u32 s57, s57, 4096
    s_waitcnt vmcnt(7)
    s_mov_b32 m0, s57
    s_nop 0
    buffer_load_dwordx4 v5, s[28:31], s56 offen lds
    s_add_u32 s56, s56, 57344
    s_add_u32 s57, s57, 4096
    s_cmp_lt_u32 s23, 16
    s_cbranch_scc1 H_NOWARM3
    s_sub_u32 s61, s23, 16
    s_lshl_b32 s61, s61, 3
    s_add_u32 s61, s61, s22
    s_mul_i32 s61, s61, 14336
    s_lshl_b32 s62, s21, 12
    s_add_u32 s61, s61, s62
    buffer_load_dwordx4 v[64:67], v7, s[32:35], s61 offen offset:0
    buffer_load_dwordx4 v[64:67], v7, s[32:35], s61 offen offset:1024
    buffer_load_dwordx4 v[64:67], v7, s[32:35], s61 offen offset:2048
    buffer_load_dwordx4 v[64:67], v7, s[32:35], s61 offen offset:3072
H_NOWARM3:
    v_mov_b32 v12, 162880
LW15:
    ds_read_b32 v14, v12 offset:12
    s_waitcnt lgkmcnt(0)
    v_readfirstlane_b32 s27, v14
    s_cmp_eq_u32 s24, 0
    s_cbranch_scc1 LW15_X
    s_sub_u32 s24, s24, 1
    s_cmp_lt_u32 s27, 1
    s_cbranch_scc1 LW15
LW15_X:
    s_waitcnt vmcnt(7)
    s_mov_b32 m0, s57
    s_nop 0
    buffer_load_dwordx4 v5, s[28:31], s56 offen lds
    s_add_u32 s56, s56, 57344
    s_add_u32 s57, s57, 4096
    s_waitcnt vmcnt(7)
    s_mov_b32 m0, s57
    s_nop 0
    buffer_load_dwordx4 v5, s[28:31], s56 offen lds
    s_add_u32 s56, s56, 57344
    s_add_u32 s57, s57, 4096
    s_waitcnt vmcnt(7)
    s_mov_b32 m0, s57
    s_nop 0
    buffer_load_dwordx4 v5, s[28:31], s56 offen lds
    s_add_u32 s56, s56, 57344
    s_add_u32 s57, s57, 4096
    s_waitcnt vmcnt(7)
    s_mov_b32 m0, s57
    s_nop 0
    buffer_load_dwordx4 v5, s[28:31], s56 offen lds
    s_add_u32 s56, s56, 57344
    s_add_u32 s57, s57, 4096
    s_waitcnt vmcnt(7)
    s_mov_b32 m0, s57
    s_nop 0
    buffer_load_dwordx4 v5, s[28:31], s56 offen lds
    s_add_u32 s56, s56, 57344
    s_add_u32 s57, s57, 4096
    s_waitcnt vmcnt(7)
    s_mov_b32 m0, s57
    s_nop 0
    buffer_load_dwordx4 v5, s[28:31], s56 offen lds
    s_add_u32 s56, s56, 57344
    s_add_u32 s57, s57, 4096
    s_waitcnt vmcnt(7)
    s_mov_b32 m0, s57
    s_nop 0
    buffer_load_dwordx4 v5, s[28:31], s56 offen lds
    s_add_u32 s56, s56, 57344
    s_add_u32 s57, s57, 4096
    s_waitcnt vmcnt(7)
    s_mov_b32 m0, s57
    s_nop 0
    buffer_load_dwordx4 v5, s[28:31], s56 offen lds
    s_add_u32 s56, s56, 57344
    s_add_u32 s57, s57, 4096
    s_waitcnt vmcnt(7)
    s_mov_b32 m0, s57
    s_nop 0
    buffer_load_dwordx4 v5, s[28:31], s56 offen lds
    s_add_u32 s56, s56, 57344
    s_add_u32 s57, s57, 4096
    s_waitcnt vmcnt(7)
    s_mov_b32 m0, s57
    s_nop 0
    buffer_load_dwordx4 v5, s[28:31], s56 offen lds
    s_add_u32 s56, s56, 57344
    s_add_u32 s57, s57, 4096
    s_waitcnt vmcnt(7)
    s_mov_b32 m0, s57
    s_nop 0
    buffer_load_dwordx4 v5, s[28:31], s56 offen lds
    s_add_u32 s56, s56, 57344
    s_add_u32 s57, s57, 4096
    s_waitcnt vmcnt(7)
    s_mov_b32 m0, s57
    s_nop 0
    buffer_load_dwordx4 v5, s[28:31], s56 offen lds
    s_add_u32 s56, s56, 57344
    s_add_u32 s57, s57, 4096
    s_waitcnt vmcnt(7)
    s_mov_b32 m0, s57
    s_nop 0
    buffer_load_dwordx4 v5, s[28:31], s56 offen lds
    s_add_u32 s56, s56, 57344
    s_add_u32 s57, s57, 4096
    s_waitcnt vmcnt(7)
    s_mov_b32 m0, s57
    s_nop 0
    buffer_load_dwordx4 v5, s[28:31], s56 offen lds
    s_add_u32 s56, s56, 57344
    s_add_u32 s57, s57, 4096
    s_waitcnt vmcnt(0)
    v_mov_b32 v12, 162880
    v_mov_b32 v13, 1
    s_mov_b64 exec, 1
    ds_add_u32 v12, v13 offset:32
    s_mov_b64 exec, -1
    s_mul_i32 s58, s2, 7168
    s_lshl_b32 s52, s21, 11
    s_add_u32 s58, s58, s52
    buffer_load_dwordx4 v[8:11], v7, s[32:35], s58 offen offset:0
    buffer_load_dwordx4 v[8:11], v7, s[32:35], s58 offen offset:1024
    s_lshr_b32 s55, s55, 1
    v_lshrrev_b32 v4, 3, v1
    v_and_b32 v5, 7, v1
    v_bfe_u32 v6, v1, 4, 1
    v_lshlrev_b32 v6, 1, v6
    s_and_b32 s52, s21, 1
    s_lshl_b32 s52, s52, 2
    v_xor_b32 v6, s52, v6
    v_xor_b32 v5, v5, v6
    v_lshlrev_b32 v4, 10, v4
    s_lshl_b32 s52, s55, 7
    v_add_u32 v4, s52, v4
    v_lshl_add_u32 v5, v5, 4, v4
LW16:
    ds_read_b32 v14, v12 offset:64
    s_waitcnt lgkmcnt(0)
    v_readfirstlane_b32 s27, v14
    s_cmp_eq_u32 s24, 0
    s_cbranch_scc1 LW16_X
    s_sub_u32 s24, s24, 1
    s_cmp_lt_u32 s27, 4
    s_cbranch_scc1 LW16
LW16_X:
    s_lshl_b32 s61, s21, 13
    s_add_u32 s61, s61, 0
    s_lshl_b32 s62, s21, 10
    s_add_u32 s62, s62, 0
    s_mov_b32 m0, s62
    s_nop 0
    buffer_load_dwordx4 v5, s[32:35], s61 offen lds
    s_add_u32 s61, s61, 32768
    s_add_u32 s62, s62, 4096
    s_mov_b32 m0, s62
    s_nop 0
    buffer_load_dwordx4 v5, s[32:35], s61 offen lds
    s_add_u32 s61, s61, 32768
    s_add_u32 s62, s62, 4096
    s_mov_b32 m0, s62
    s_nop 0
    buffer_load_dwordx4 v5, s[32:35], s61 offen lds
    s_add_u32 s61, s61, 32768
    s_add_u32 s62, s62, 4096
    s_mov_b32 m0, s62
    s_nop 0
    buffer_load_dwordx4 v5, s[32:35], s61 offen lds
    s_add_u32 s61, s61, 32768
    s_add_u32 s62, s62, 4096
    s_mov_b32 m0, s62
    s_nop 0
    buffer_load_dwordx4 v5, s[32:35], s61 offen lds
    s_add_u32 s61, s61, 32768
    s_add_u32 s62, s62, 4096
    s_mov_b32 m0, s62
    s_nop 0
    buffer_load_dwordx4 v5, s[32:35], s61 offen lds
    s_add_u32 s61, s61, 32768
    s_add_u32 s62, s62, 4096
    s_mov_b32 m0, s62
    s_nop 0
    buffer_load_dwordx4 v5, s[32:35], s61 offen lds
    s_add_u32 s61, s61, 32768
    s_add_u32 s62, s62, 4096
    s_mov_b32 m0, s62
    s_nop 0
    buffer_load_dwordx4 v5, s[32:35], s61 offen lds
    s_add_u32 s61, s61, 32768
    s_add_u32 s62, s62, 4096
    s_mov_b32 m0, s62
    s_nop 0
    buffer_load_dwordx4 v5, s[32:35], s61 offen lds
    s_add_u32 s61, s61, 32768
    s_add_u32 s62, s62, 4096
LW17:
    ds_read_b32 v14, v12 offset:68
    s_waitcnt lgkmcnt(0)
    v_readfirstlane_b32 s27, v14
    s_cmp_eq_u32 s24, 0
    s_cbranch_scc1 LW17_X
    s_sub_u32 s24, s24, 1
    s_cmp_lt_u32 s27, 4
    s_cbranch_scc1 LW17
LW17_X:
    s_lshl_b32 s61, s21, 13
    s_add_u32 s61, s61, 458752
    s_lshl_b32 s62, s21, 10
    s_add_u32 s62, s62, 36864
    s_mov_b32 m0, s62
    s_nop 0
    buffer_load_dwordx4 v5, s[32:35], s61 offen lds
    s_add_u32 s61, s61, 32768
    s_add_u32 s62, s62, 4096
    s_mov_b32 m0, s62
    s_nop 0
    buffer_load_dwordx4 v5, s[32:35], s61 offen lds
    s_add_u32 s61, s61, 32768
    s_add_u32 s62, s62, 4096
    s_mov_b32 m0, s62
    s_nop 0
    buffer_load_dwordx4 v5, s[32:35], s61 offen lds
    s_add_u32 s61, s61, 32768
    s_add_u32 s62, s62, 4096
    s_mov_b32 m0, s62
    s_nop 0
    buffer_load_dwordx4 v5, s[32:35], s61 offen lds
    s_add_u32 s61, s61, 32768
    s_add_u32 s62, s62, 4096
    s_mov_b32 m0, s62
    s_nop 0
    buffer_load_dwordx4 v5, s[32:35], s61 offen lds
    s_add_u32 s61, s61, 32768
    s_add_u32 s62, s62, 4096
    s_waitcnt vmcnt(15)
    s_mov_b32 m0, s62
    s_nop 0
    buffer_load_dwordx4 v5, s[32:35], s61 offen lds
    s_add_u32 s61, s61, 32768
    s_add_u32 s62, s62, 4096
    s_waitcnt vmcnt(15)
    s_mov_b32 m0, s62
    s_nop 0
    buffer_load_dwordx4 v5, s[32:35], s61 offen lds
    s_add_u32 s61, s61, 32768
    s_add_u32 s62, s62, 4096
    s_waitcnt vmcnt(15)
    s_mov_b32 m0, s62
    s_nop 0
    buffer_load_dwordx4 v5, s[32:35], s61 offen lds
    s_add_u32 s61, s61, 32768
    s_add_u32 s62, s62, 4096
    s_waitcnt vmcnt(15)
    s_mov_b32 m0, s62
    s_nop 0
    buffer_load_dwordx4 v5, s[32:35], s61 offen lds
    s_add_u32 s61, s61, 32768
    s_add_u32 s62, s62, 4096
LW18:
    ds_read_b32 v14, v12 offset:72
    s_waitcnt lgkmcnt(0)
    v_readfirstlane_b32 s27, v14
    s_cmp_eq_u32 s24, 0
    s_cbranch_scc1 LW18_X
    s_sub_u32 s24, s24, 1
    s_cmp_lt_u32 s27, 4
    s_cbranch_scc1 LW18
LW18_X:
    s_lshl_b32 s61, s21, 13
    s_add_u32 s61, s61, 917504
    s_lshl_b32 s62, s21, 10
    s_add_u32 s62, s62, 73728
    s_waitcnt vmcnt(15)
    s_mov_b32 m0, s62
    s_nop 0
    buffer_load_dwordx4 v5, s[32:35], s61 offen lds
    s_add_u32 s61, s61, 32768
    s_add_u32 s62, s62, 4096
    s_waitcnt vmcnt(15)
    s_mov_b32 m0, s62
    s_nop 0
    buffer_load_dwordx4 v5, s[32:35], s61 offen lds
    s_add_u32 s61, s61, 32768
    s_add_u32 s62, s62, 4096
    s_waitcnt vmcnt(15)
    s_mov_b32 m0, s62
    s_nop 0
    buffer_load_dwordx4 v5, s[32:35], s61 offen lds
    s_add_u32 s61, s61, 32768
    s_add_u32 s62, s62, 4096
    s_waitcnt vmcnt(15)
    s_mov_b32 m0, s62
    s_nop 0
    buffer_load_dwordx4 v5, s[32:35], s61 offen lds
    s_add_u32 s61, s61, 32768
    s_add_u32 s62, s62, 4096
    s_waitcnt vmcnt(15)
    s_mov_b32 m0, s62
    s_nop 0
    buffer_load_dwordx4 v5, s[32:35], s61 offen lds
    s_add_u32 s61, s61, 32768
    s_add_u32 s62, s62, 4096
    s_waitcnt vmcnt(15)
    s_mov_b32 m0, s62
    s_nop 0
    buffer_load_dwordx4 v5, s[32:35], s61 offen lds
    s_add_u32 s61, s61, 32768
    s_add_u32 s62, s62, 4096
    s_waitcnt vmcnt(15)
    s_mov_b32 m0, s62
    s_nop 0
    buffer_load_dwordx4 v5, s[32:35], s61 offen lds
    s_add_u32 s61, s61, 32768
    s_add_u32 s62, s62, 4096
    s_waitcnt vmcnt(15)
    s_mov_b32 m0, s62
    s_nop 0
    buffer_load_dwordx4 v5, s[32:35], s61 offen lds
    s_add_u32 s61, s61, 32768
    s_add_u32 s62, s62, 4096
    s_waitcnt vmcnt(15)
    s_mov_b32 m0, s62
    s_nop 0
    buffer_load_dwordx4 v5, s[32:35], s61 offen lds
    s_add_u32 s61, s61, 32768
    s_add_u32 s62, s62, 4096
LW19:
    ds_read_b32 v14, v12 offset:36
    s_waitcnt lgkmcnt(0)
    v_readfirstlane_b32 s27, v14
    s_cmp_eq_u32 s24, 0
    s_cbranch_scc1 LW19_X
    s_sub_u32 s24, s24, 1
    s_cmp_lt_u32 s27, 4
    s_cbranch_scc1 LW19
LW19_X:
    s_lshl_b32 s61, s21, 13
    s_add_u32 s61, s61, 1376256
    s_lshl_b32 s62, s21, 10
    s_add_u32 s62, s62, 110592
    s_waitcnt vmcnt(15)
    s_mov_b32 m0, s62
    s_nop 0
    buffer_load_dwordx4 v5, s[32:35], s61 offen lds
    s_add_u32 s61, s61, 32768
    s_add_u32 s62, s62, 4096
    s_waitcnt vmcnt(15)
    s_mov_b32 m0, s62
    s_nop 0
    buffer_load_dwordx4 v5, s[32:35], s61 offen lds
    s_add_u32 s61, s61, 32768
    s_add_u32 s62, s62, 4096
    s_waitcnt vmcnt(15)
    s_mov_b32 m0, s62
    s_nop 0
    buffer_load_dwordx4 v5, s[32:35], s61 offen lds
    s_add_u32 s61, s61, 32768
    s_add_u32 s62, s62, 4096
    s_waitcnt vmcnt(15)
    s_mov_b32 m0, s62
    s_nop 0
    buffer_load_dwordx4 v5, s[32:35], s61 offen lds
    s_add_u32 s61, s61, 32768
    s_add_u32 s62, s62, 4096
    s_waitcnt vmcnt(15)
    s_mov_b32 m0, s62
    s_nop 0
    buffer_load_dwordx4 v5, s[32:35], s61 offen lds
    s_add_u32 s61, s61, 32768
    s_add_u32 s62, s62, 4096
    s_waitcnt vmcnt(15)
    s_mov_b32 m0, s62
    s_nop 0
    buffer_load_dwordx4 v5, s[32:35], s61 offen lds
    s_add_u32 s61, s61, 32768
    s_add_u32 s62, s62, 4096
    s_waitcnt vmcnt(15)
    s_mov_b32 m0, s62
    s_nop 0
    buffer_load_dwordx4 v5, s[32:35], s61 offen lds
    s_add_u32 s61, s61, 32768
    s_add_u32 s62, s62, 4096
    s_waitcnt vmcnt(15)
    s_mov_b32 m0, s62
    s_nop 0
    buffer_load_dwordx4 v5, s[32:35], s61 offen lds
    s_add_u32 s61, s61, 32768
    s_add_u32 s62, s62, 4096
    s_waitcnt vmcnt(15)
    s_mov_b32 m0, s62
    s_nop 0
    buffer_load_dwordx4 v5, s[32:35], s61 offen lds
    s_add_u32 s61, s61, 32768
    s_add_u32 s62, s62, 4096
    s_waitcnt vmcnt(0)
    s_mov_b64 exec, 1
    ds_add_u32 v12, v13 offset:48
    s_mov_b64 exec, -1
LW20:
    ds_read_b32 v14, v12 offset:100
    s_waitcnt lgkmcnt(0)
    v_readfirstlane_b32 s27, v14
    s_cmp_eq_u32 s24, 0
    s_cbranch_scc1 LW20_X
    s_sub_u32 s24, s24, 1
    s_cmp_lt_u32 s27, 4
    s_cbranch_scc1 LW20
LW20_X:
    s_lshl_b32 s61, s21, 13
    s_add_u32 s61, s61, 294912
    s_lshl_b32 s62, s21, 10
    s_add_u32 s62, s62, 0
    s_mov_b32 m0, s62
    s_nop 0
    buffer_load_dwordx4 v5, s[32:35], s61 offen lds
    s_add_u32 s61, s61, 32768
    s_add_u32 s62, s62, 4096
    s_mov_b32 m0, s62
    s_nop 0
    buffer_load_dwordx4 v5, s[32:35], s61 offen lds
    s_add_u32 s61, s61, 32768
    s_add_u32 s62, s62, 4096
    s_mov_b32 m0, s62
    s_nop 0
    buffer_load_dwordx4 v5, s[32:35], s61 offen lds
    s_add_u32 s61, s61, 32768
    s_add_u32 s62, s62, 4096
    s_mov_b32 m0, s62
    s_nop 0
    buffer_load_dwordx4 v5, s[32:35], s61 offen lds
    s_add_u32 s61, s61, 32768
    s_add_u32 s62, s62, 4096
    s_mov_b32 m0, s62
    s_nop 0
    buffer_load_dwordx4 v5, s[32:35], s61 offen lds
    s_add_u32 s61, s61, 32768
    s_add_u32 s62, s62, 4096
    s_lshl_b32 s61, s21, 13
    s_add_u32 s61, s61, 753664
    s_lshl_b32 s62, s21, 10
    s_add_u32 s62, s62, 36864
    s_mov_b32 m0, s62
    s_nop 0
    buffer_load_dwordx4 v5, s[32:35], s61 offen lds
    s_add_u32 s61, s61, 32768
    s_add_u32 s62, s62, 4096
    s_mov_b32 m0, s62
    s_nop 0
    buffer_load_dwordx4 v5, s[32:35], s61 offen lds
    s_add_u32 s61, s61, 32768
    s_add_u32 s62, s62, 4096
    s_mov_b32 m0, s62
    s_nop 0
    buffer_load_dwordx4 v5, s[32:35], s61 offen lds
    s_add_u32 s61, s61, 32768
    s_add_u32 s62, s62, 4096
    s_mov_b32 m0, s62
    s_nop 0
    buffer_load_dwordx4 v5, s[32:35], s61 offen lds
    s_add_u32 s61, s61, 32768
    s_add_u32 s62, s62, 4096
    s_mov_b32 m0, s62
    s_nop 0
    buffer_load_dwordx4 v5, s[32:35], s61 offen lds
    s_add_u32 s61, s61, 32768
    s_add_u32 s62, s62, 4096
    s_lshl_b32 s61, s21, 13
    s_add_u32 s61, s61, 1212416
    s_lshl_b32 s62, s21, 10
    s_add_u32 s62, s62, 73728
    s_mov_b32 m0, s62
    s_nop 0
    buffer_load_dwordx4 v5, s[32:35], s61 offen lds
    s_add_u32 s61, s61, 32768
    s_add_u32 s62, s62, 4096
    s_mov_b32 m0, s62
    s_nop 0
    buffer_load_dwordx4 v5, s[32:35], s61 offen lds
    s_add_u32 s61, s61, 32768
    s_add_u32 s62, s62, 4096
    s_mov_b32 m0, s62
    s_nop 0
    buffer_load_dwordx4 v5, s[32:35], s61 offen lds
    s_add_u32 s61, s61, 32768
    s_add_u32 s62, s62, 4096
    s_mov_b32 m0, s62
    s_nop 0
    buffer_load_dwordx4 v5, s[32:35], s61 offen lds
    s_add_u32 s61, s61, 32768
    s_add_u32 s62, s62, 4096
    s_mov_b32 m0, s62
    s_nop 0
    buffer_load_dwordx4 v5, s[32:35], s61 offen lds
    s_add_u32 s61, s61, 32768
    s_add_u32 s62, s62, 4096
    s_lshl_b32 s61, s21, 13
    s_add_u32 s61, s61, 1671168
    s_lshl_b32 s62, s21, 10
    s_add_u32 s62, s62, 110592
    s_mov_b32 m0, s62
    s_nop 0
    buffer_load_dwordx4 v5, s[32:35], s61 offen lds
    s_add_u32 s61, s61, 32768
    s_add_u32 s62, s62, 4096
    s_mov_b32 m0, s62
    s_nop 0
    buffer_load_dwordx4 v5, s[32:35], s61 offen lds
    s_add_u32 s61, s61, 32768
    s_add_u32 s62, s62, 4096
    s_mov_b32 m0, s62
    s_nop 0
    buffer_load_dwordx4 v5, s[32:35], s61 offen lds
    s_add_u32 s61, s61, 32768
    s_add_u32 s62, s62, 4096
    s_mov_b32 m0, s62
    s_nop 0
    buffer_load_dwordx4 v5, s[32:35], s61 offen lds
    s_add_u32 s61, s61, 32768
    s_add_u32 s62, s62, 4096
    s_mov_b32 m0, s62
    s_nop 0
    buffer_load_dwordx4 v5, s[32:35], s61 offen lds
    s_add_u32 s61, s61, 32768
    s_add_u32 s62, s62, 4096
    s_waitcnt vmcnt(0)
    s_mov_b64 exec, 1
    ds_add_u32 v12, v13 offset:104
    s_mov_b64 exec, -1
L_END:
    s_endpgm
L_CODE_END:
.section .rodata,"a"
.p2align 6
.amdhsa_kernel adaLN_cond__spectral_fnet__dense_activation_relu__prompt_kernel
  .amdhsa_next_free_vgpr 256
  .amdhsa_next_free_sgpr 102
  .amdhsa_accum_offset 256
  .amdhsa_group_segment_fixed_size 0
  .amdhsa_kernarg_size 104
  .amdhsa_user_sgpr_count 2
  .amdhsa_user_sgpr_kernarg_segment_ptr 1
  .amdhsa_system_sgpr_workgroup_id_x 1
  .amdhsa_float_denorm_mode_32 3
.end_amdhsa_kernel
```
